```python
import torch

def _softmax(x, axis=-1):
    return torch.softmax(x, dim=axis)
def _gelu(x):
    return torch.nn.functional.gelu(x, approximate="tanh")
def _silu(x):
    return torch.nn.functional.silu(x)
def _sigmoid(x):
    return torch.sigmoid(x)
def _layernorm(x, axis=-1, eps=1e-5):
    m = x.mean(dim=axis, keepdim=True)
    v = x.var(dim=axis, keepdim=True, unbiased=False)
    return (x - m) / torch.sqrt(v + eps)
def _scatter_add(tgt, idx, src, axis=0):
    return tgt.clone().index_add_(axis, idx, src)
def _segment_sum(src, seg, n):
    out = torch.zeros((n,) + src.shape[1:], dtype=src.dtype)
    return out.index_add_(0, seg, src)
def _pad(x, pw):
    flat = tuple(v for pair in reversed(pw) for v in pair)
    return torch.nn.functional.pad(x, flat)

kernel_name = 'gated_mix__linear_attn_block__dense_activation_relu__prompt'

def setup_inputs():

    _w = (lambda a: (lambda t: t.to(torch.bfloat16) if t.is_floating_point() else t)(torch.as_tensor(a)))
    def _A_setup():
        B, S, D = 1, 2048, 640
        return {
            "x": _w((lambda *s: torch.randn(*s, dtype=torch.bfloat16) * 0.05)(B, S, D)),
            "wqkv": _w((lambda *s: torch.randn(*s, dtype=torch.bfloat16) * 0.8)(D, 3 * D)),
            "wo": _w((lambda *s: torch.randn(*s, dtype=torch.bfloat16) * 0.2)(D, D)),
        }
    _A_in = _A_setup()

    def _B_setup():
        B, S, D, Dff = 1, 2048, 640, 1536
        return {
            "x": _w((lambda *s: torch.randn(*s, dtype=torch.bfloat16) * 0.05)(B, S, D)),
            "w1": _w((lambda *s: torch.randn(*s, dtype=torch.bfloat16) * 0.05)(D, Dff)),
            "w2": _w((lambda *s: torch.randn(*s, dtype=torch.bfloat16) * 0.05)(Dff, D)),
        }
    _B_in = _B_setup()

    return {
        "A_x": _A_in["x"],
        "A_wqkv": _A_in["wqkv"],
        "A_wo": _A_in["wo"],
        "B_x": _B_in["x"],
        "B_w1": _B_in["w1"],
        "B_w2": _B_in["w2"],
        "gate_w": _w((lambda *s: torch.randn(*s, dtype=torch.bfloat16) * 0.05)(640) * 16.0),
    }

def reference(A_x, A_wqkv, A_wo, B_x, B_w1, B_w2, gate_w):
    def _A_ref(x, wqkv, wo):
        B, S, D = x.shape
        H = 32; Dh = D // H
        qkv = (lambda x, *d: x.permute(*d))((x @ wqkv).reshape(B, S, 3, H, Dh), 2, 0, 3, 1, 4)
        q, k, v = qkv[0], qkv[1], qkv[2]
        phi = lambda t: torch.where(t > 0, t + 1, torch.exp(t)) + 1e-6
        pq, pk = phi(q), phi(k)
        kv = torch.einsum("bhsd,bhse->bhde", pk, v)
        z = torch.einsum("bhsd->bhd", pk)
        num = torch.einsum("bhqd,bhde->bhqe", pq, kv)
        den = torch.einsum("bhqd,bhd->bhq", pq, z)[..., None] + 1e-6
        o = num / den
        return (lambda x, *d: x.permute(*d))(o, 0, 2, 1, 3).reshape(B, S, D) @ wo

    def _B_ref(x, w1, w2):
        h = torch.einsum("bsd,df->bsf", x, w1)
        zero = torch.zeros_like(h)
        h = torch.maximum(h, zero)
        return torch.einsum("bsf,fd->bsd", h, w2)

    x = A_x
    g = _sigmoid((x * gate_w).sum(-1, keepdims=True))
    a = _A_ref(x, A_wqkv, A_wo)
    b = _B_ref(x, B_w1, B_w2)
    return g * a + (1 - g) * b
```

```asm
; @launch grid=(256,1,1) block=(512,1,1) lds=161792
.amdgcn_target "amdgcn-amd-amdhsa--gfx950"
.text
.globl gated_mix__linear_attn_block__dense_activation_relu__prompt_kernel
.p2align 8
.type gated_mix__linear_attn_block__dense_activation_relu__prompt_kernel,@function
gated_mix__linear_attn_block__dense_activation_relu__prompt_kernel:
s_cmp_ge_u32 s2, 256
s_cbranch_scc1 L_end
s_load_dwordx16 s[4:19], s[0:1], 0
s_load_dwordx4 s[20:23], s[0:1], 64
s_getpc_b64 s[74:75]
v_and_b32 v1, 63, v0
v_lshrrev_b32 v2, 6, v0
s_nop 0
v_readfirstlane_b32 s24, v2
s_and_b32 s44, s2, 7
s_lshr_b32 s31, s2, 3
s_lshr_b32 s73, s44, 1
s_and_b32 s3, s44, 1
s_and_b32 s28, s31, 1
s_lshr_b32 s45, s31, 1
s_and_b32 s26, s45, 3
s_lshl_b32 s46, s73, 2
s_add_u32 s26, s26, s46
s_lshr_b32 s27, s45, 2
s_lshl_b32 s46, s3, 2
s_add_u32 s27, s27, s46
s_lshl_b32 s29, s26, 1
s_add_u32 s29, s29, s28
s_and_b32 s25, s24, 3
s_mov_b32 s72, 0
s_waitcnt lgkmcnt(0)
s_mov_b32 s40, s22
s_mov_b32 s41, s23
s_mov_b32 s42, 17825792
s_mov_b32 s43, 0x20000
s_cmp_ge_u32 s24, 4
s_cbranch_scc0 L_compute
s_cmp_eq_u32 s28, 0
s_cbranch_scc0 L_helper_h
s_mul_i32 s44, s26, 163840
s_add_u32 s32, s4, s44
s_addc_u32 s33, s5, 0
s_sub_u32 s34, 2621440, s44
s_mov_b32 s35, 0x20000
v_lshrrev_b32 v2, 3, v1
v_and_b32 v3, 7, v1
v_xor_b32 v4, v3, v2
v_lshlrev_b32 v4, 4, v4
s_lshl_b32 s44, s25, 5
v_add_u32 v5, s44, v2
v_mul_u32_u24 v5, 1280, v5
v_add_u32 v8, v5, v4
v_add_u32 v9, 10240, v8
v_add_u32 v10, 20480, v8
v_add_u32 v11, 30720, v8
s_lshl_b32 s48, s25, 12
s_add_u32 s49, s48, 1024
s_add_u32 s50, s48, 2048
s_add_u32 s51, s48, 3072
s_mov_b32 s60, 0
s_and_b32 s45, s27, 3
s_lshl_b32 s45, s45, 1
s_add_u32 s59, s45, s28
s_and_b32 s45, s26, 3
s_mul_i32 s45, s45, 3
s_add_u32 s59, s59, s45
s_cmp_ge_u32 s59, 10
s_cselect_b32 s45, 10, 0
s_sub_u32 s59, s59, s45
s_lshl_b32 s61, s59, 7
s_mul_i32 s62, s59, 245760
s_mul_i32 s66, s59, 245760
s_mov_b32 m0, s48
s_nop 0
buffer_load_dwordx4 v8, s[32:35], s61 offen lds
s_mov_b32 m0, s49
s_nop 0
buffer_load_dwordx4 v9, s[32:35], s61 offen lds
s_mov_b32 m0, s50
s_nop 0
buffer_load_dwordx4 v10, s[32:35], s61 offen lds
s_mov_b32 m0, s51
s_nop 0
buffer_load_dwordx4 v11, s[32:35], s61 offen lds
s_mul_i32 s44, s27, 160
s_add_u32 s44, s44, 1280
s_add_u32 s36, s6, s44
s_addc_u32 s37, s7, 0
s_sub_u32 s38, 2457600, s44
s_mov_b32 s39, 0x20000
s_add_u32 s44, s25, 0
s_cmp_ge_u32 s44, 10
s_cselect_b32 s45, 1, 0
s_mul_i32 s46, s45, 10
s_sub_u32 s46, s44, s46
s_lshl_b32 s47, s46, 6
v_add_u32 v2, s47, v1
v_mul_u32_u24 v3, 6554, v2
v_lshrrev_b32 v3, 16, v3
v_mul_u32_u24 v4, 10, v3
v_sub_u32 v4, v2, v4
v_and_b32 v5, 0x33, v3
v_and_b32 v6, 4, v3
v_lshl_or_b32 v5, v6, 1, v5
v_and_b32 v6, 8, v3
v_lshrrev_b32 v6, 1, v6
v_or_b32 v5, v5, v6
v_mul_u32_u24 v5, 3840, v5
v_lshl_add_u32 v12, v4, 4, v5
s_mul_i32 s47, s45, 1280
v_add_u32 v12, s47, v12
s_mul_i32 s47, s45, 10256
s_lshl_b32 s46, s46, 10
s_add_u32 s47, s47, s46
s_add_u32 s52, s47, 16384
s_mov_b32 m0, s52
s_nop 0
buffer_load_dwordx4 v12, s[36:39], s62 offen lds
s_add_u32 s44, s25, 4
s_cmp_ge_u32 s44, 10
s_cselect_b32 s45, 1, 0
s_mul_i32 s46, s45, 10
s_sub_u32 s46, s44, s46
s_lshl_b32 s47, s46, 6
v_add_u32 v2, s47, v1
v_mul_u32_u24 v3, 6554, v2
v_lshrrev_b32 v3, 16, v3
v_mul_u32_u24 v4, 10, v3
v_sub_u32 v4, v2, v4
v_and_b32 v5, 0x33, v3
v_and_b32 v6, 4, v3
v_lshl_or_b32 v5, v6, 1, v5
v_and_b32 v6, 8, v3
v_lshrrev_b32 v6, 1, v6
v_or_b32 v5, v5, v6
v_mul_u32_u24 v5, 3840, v5
v_lshl_add_u32 v13, v4, 4, v5
s_mul_i32 s47, s45, 1280
v_add_u32 v13, s47, v13
s_mul_i32 s47, s45, 10256
s_lshl_b32 s46, s46, 10
s_add_u32 s47, s47, s46
s_add_u32 s53, s47, 16384
s_mov_b32 m0, s53
s_nop 0
buffer_load_dwordx4 v13, s[36:39], s62 offen lds
s_add_u32 s44, s25, 8
s_cmp_ge_u32 s44, 10
s_cselect_b32 s45, 1, 0
s_mul_i32 s46, s45, 10
s_sub_u32 s46, s44, s46
s_lshl_b32 s47, s46, 6
v_add_u32 v2, s47, v1
v_mul_u32_u24 v3, 6554, v2
v_lshrrev_b32 v3, 16, v3
v_mul_u32_u24 v4, 10, v3
v_sub_u32 v4, v2, v4
v_and_b32 v5, 0x33, v3
v_and_b32 v6, 4, v3
v_lshl_or_b32 v5, v6, 1, v5
v_and_b32 v6, 8, v3
v_lshrrev_b32 v6, 1, v6
v_or_b32 v5, v5, v6
v_mul_u32_u24 v5, 3840, v5
v_lshl_add_u32 v14, v4, 4, v5
s_mul_i32 s47, s45, 1280
v_add_u32 v14, s47, v14
s_mul_i32 s47, s45, 10256
s_lshl_b32 s46, s46, 10
s_add_u32 s47, s47, s46
s_add_u32 s54, s47, 16384
s_mov_b32 m0, s54
s_nop 0
buffer_load_dwordx4 v14, s[36:39], s62 offen lds
s_add_u32 s44, s25, 12
s_cmp_ge_u32 s44, 10
s_cselect_b32 s45, 1, 0
s_mul_i32 s46, s45, 10
s_sub_u32 s46, s44, s46
s_lshl_b32 s47, s46, 6
v_add_u32 v2, s47, v1
v_mul_u32_u24 v3, 6554, v2
v_lshrrev_b32 v3, 16, v3
v_mul_u32_u24 v4, 10, v3
v_sub_u32 v4, v2, v4
v_and_b32 v5, 0x33, v3
v_and_b32 v6, 4, v3
v_lshl_or_b32 v5, v6, 1, v5
v_and_b32 v6, 8, v3
v_lshrrev_b32 v6, 1, v6
v_or_b32 v5, v5, v6
v_mul_u32_u24 v5, 3840, v5
v_lshl_add_u32 v15, v4, 4, v5
s_mul_i32 s47, s45, 1280
v_add_u32 v15, s47, v15
s_mul_i32 s47, s45, 10256
s_lshl_b32 s46, s46, 10
s_add_u32 s47, s47, s46
s_add_u32 s55, s47, 16384
s_mov_b32 m0, s55
s_nop 0
buffer_load_dwordx4 v15, s[36:39], s62 offen lds
s_add_u32 s44, s25, 16
s_cmp_ge_u32 s44, 10
s_cselect_b32 s45, 1, 0
s_mul_i32 s46, s45, 10
s_sub_u32 s46, s44, s46
s_lshl_b32 s47, s46, 6
v_add_u32 v2, s47, v1
v_mul_u32_u24 v3, 6554, v2
v_lshrrev_b32 v3, 16, v3
v_mul_u32_u24 v4, 10, v3
v_sub_u32 v4, v2, v4
v_and_b32 v5, 0x33, v3
v_and_b32 v6, 4, v3
v_lshl_or_b32 v5, v6, 1, v5
v_and_b32 v6, 8, v3
v_lshrrev_b32 v6, 1, v6
v_or_b32 v5, v5, v6
v_mul_u32_u24 v5, 3840, v5
v_lshl_add_u32 v16, v4, 4, v5
s_mul_i32 s47, s45, 1280
v_add_u32 v16, s47, v16
s_mul_i32 s47, s45, 10256
s_lshl_b32 s46, s46, 10
s_add_u32 s47, s47, s46
s_add_u32 s56, s47, 16384
s_mov_b32 m0, s56
s_nop 0
buffer_load_dwordx4 v16, s[36:39], s62 offen lds
s_mul_i32 s44, s27, 160
s_add_u32 s68, s6, s44
s_addc_u32 s69, s7, 0
s_sub_u32 s70, 2457600, s44
s_mov_b32 s71, 0x20000
s_mul_i32 s44, s25, 160
s_mul_i32 s67, s25, 2560
s_add_u32 s67, s67, 40960
v_add_u32 v2, s44, v1
v_min_u32 v2, 639, v2
v_mul_u32_u24 v3, 6554, v2
v_lshrrev_b32 v3, 16, v3
v_mul_u32_u24 v4, 10, v3
v_sub_u32 v4, v2, v4
v_and_b32 v5, 0x33, v3
v_and_b32 v6, 4, v3
v_lshl_or_b32 v5, v6, 1, v5
v_and_b32 v6, 8, v3
v_lshrrev_b32 v6, 1, v6
v_or_b32 v5, v5, v6
v_mul_u32_u24 v5, 3840, v5
v_lshl_add_u32 v20, v4, 4, v5
v_add_u32 v2, s44, v1
v_add_u32 v2, 64, v2
v_min_u32 v2, 639, v2
v_mul_u32_u24 v3, 6554, v2
v_lshrrev_b32 v3, 16, v3
v_mul_u32_u24 v4, 10, v3
v_sub_u32 v4, v2, v4
v_and_b32 v5, 0x33, v3
v_and_b32 v6, 4, v3
v_lshl_or_b32 v5, v6, 1, v5
v_and_b32 v6, 8, v3
v_lshrrev_b32 v6, 1, v6
v_or_b32 v5, v5, v6
v_mul_u32_u24 v5, 3840, v5
v_lshl_add_u32 v21, v4, 4, v5
v_add_u32 v2, s44, v1
v_add_u32 v2, 128, v2
v_min_u32 v2, 639, v2
v_mul_u32_u24 v3, 6554, v2
v_lshrrev_b32 v3, 16, v3
v_mul_u32_u24 v4, 10, v3
v_sub_u32 v4, v2, v4
v_and_b32 v5, 0x33, v3
v_and_b32 v6, 4, v3
v_lshl_or_b32 v5, v6, 1, v5
v_and_b32 v6, 8, v3
v_lshrrev_b32 v6, 1, v6
v_or_b32 v5, v5, v6
v_mul_u32_u24 v5, 3840, v5
v_lshl_add_u32 v22, v4, 4, v5
s_add_u32 m0, s60, s67
s_nop 0
buffer_load_dwordx4 v20, s[68:71], s66 offen lds
s_add_u32 m0, m0, 1024
s_nop 0
buffer_load_dwordx4 v21, s[68:71], s66 offen lds
s_add_u32 m0, m0, 1024
s_mov_b32 exec_hi, 0
buffer_load_dwordx4 v22, s[68:71], s66 offen lds
s_mov_b64 exec, -1
s_mov_b32 s96, s16
s_mov_b32 s97, s17
s_movk_i32 s98, 1280
s_mov_b32 s99, 0x20000
v_lshlrev_b32 v2, 4, v1
s_mov_b32 m0, 159744
s_nop 0
buffer_load_dwordx4 v2, s[96:99], 0 offen lds
s_mov_b32 exec_lo, 0xffff
s_mov_b32 exec_hi, 0
buffer_load_dwordx4 v2, s[96:99], 0 offen offset:1024 lds
s_mov_b64 exec, -1
s_add_u32 s60, s60, 51200
s_cmp_eq_u32 s60, 153600
s_cselect_b32 s60, 0, s60
s_add_u32 s61, s61, 128
s_add_u32 s62, s62, 245760
s_add_u32 s66, s66, 245760
s_add_u32 s59, s59, 1
s_cmp_eq_u32 s59, 10
s_cselect_b32 s59, 0, s59
s_cselect_b32 s61, 0, s61
s_cselect_b32 s62, 0, s62
s_cselect_b32 s66, 0, s66
s_waitcnt vmcnt(0)
s_barrier
s_add_u32 m0, s60, s48
s_nop 0
buffer_load_dwordx4 v8, s[32:35], s61 offen lds
s_add_u32 m0, s60, s49
s_nop 0
buffer_load_dwordx4 v9, s[32:35], s61 offen lds
s_add_u32 m0, s60, s50
s_nop 0
buffer_load_dwordx4 v10, s[32:35], s61 offen lds
s_add_u32 m0, s60, s51
s_nop 0
buffer_load_dwordx4 v11, s[32:35], s61 offen lds
s_add_u32 m0, s60, s52
s_nop 0
buffer_load_dwordx4 v12, s[36:39], s62 offen lds
s_add_u32 m0, s60, s53
s_nop 0
buffer_load_dwordx4 v13, s[36:39], s62 offen lds
s_add_u32 m0, s60, s54
s_nop 0
buffer_load_dwordx4 v14, s[36:39], s62 offen lds
s_add_u32 m0, s60, s55
s_nop 0
buffer_load_dwordx4 v15, s[36:39], s62 offen lds
s_add_u32 m0, s60, s56
s_nop 0
buffer_load_dwordx4 v16, s[36:39], s62 offen lds
s_add_u32 m0, s60, s67
s_nop 0
buffer_load_dwordx4 v20, s[68:71], s66 offen lds
s_add_u32 m0, m0, 1024
s_nop 0
buffer_load_dwordx4 v21, s[68:71], s66 offen lds
s_add_u32 m0, m0, 1024
s_mov_b32 exec_hi, 0
buffer_load_dwordx4 v22, s[68:71], s66 offen lds
s_mov_b64 exec, -1
s_add_u32 s60, s60, 51200
s_cmp_eq_u32 s60, 153600
s_cselect_b32 s60, 0, s60
s_add_u32 s61, s61, 128
s_add_u32 s62, s62, 245760
s_add_u32 s66, s66, 245760
s_add_u32 s59, s59, 1
s_cmp_eq_u32 s59, 10
s_cselect_b32 s59, 0, s59
s_cselect_b32 s61, 0, s61
s_cselect_b32 s62, 0, s62
s_cselect_b32 s66, 0, s66
s_add_u32 m0, s60, s48
s_nop 0
buffer_load_dwordx4 v8, s[32:35], s61 offen lds
s_add_u32 m0, s60, s49
s_nop 0
buffer_load_dwordx4 v9, s[32:35], s61 offen lds
s_add_u32 m0, s60, s50
s_nop 0
buffer_load_dwordx4 v10, s[32:35], s61 offen lds
s_add_u32 m0, s60, s51
s_nop 0
buffer_load_dwordx4 v11, s[32:35], s61 offen lds
s_add_u32 m0, s60, s52
s_nop 0
buffer_load_dwordx4 v12, s[36:39], s62 offen lds
s_add_u32 m0, s60, s53
s_nop 0
buffer_load_dwordx4 v13, s[36:39], s62 offen lds
s_add_u32 m0, s60, s54
s_nop 0
buffer_load_dwordx4 v14, s[36:39], s62 offen lds
s_add_u32 m0, s60, s55
s_nop 0
buffer_load_dwordx4 v15, s[36:39], s62 offen lds
s_add_u32 m0, s60, s56
s_nop 0
buffer_load_dwordx4 v16, s[36:39], s62 offen lds
s_add_u32 m0, s60, s67
s_nop 0
buffer_load_dwordx4 v20, s[68:71], s66 offen lds
s_add_u32 m0, m0, 1024
s_nop 0
buffer_load_dwordx4 v21, s[68:71], s66 offen lds
s_add_u32 m0, m0, 1024
s_mov_b32 exec_hi, 0
buffer_load_dwordx4 v22, s[68:71], s66 offen lds
s_mov_b64 exec, -1
s_add_u32 s60, s60, 51200
s_cmp_eq_u32 s60, 153600
s_cselect_b32 s60, 0, s60
s_add_u32 s61, s61, 128
s_add_u32 s62, s62, 245760
s_add_u32 s66, s66, 245760
s_add_u32 s59, s59, 1
s_cmp_eq_u32 s59, 10
s_cselect_b32 s59, 0, s59
s_cselect_b32 s61, 0, s61
s_cselect_b32 s62, 0, s62
s_cselect_b32 s66, 0, s66
v_mov_b32 v2, 161536
ds_read_b32 v3, v2 offset:0
s_waitcnt lgkmcnt(0)
v_readfirstlane_b32 s30, v3
s_waitcnt vmcnt(12)
s_barrier
s_add_u32 m0, s60, s48
s_nop 0
buffer_load_dwordx4 v8, s[32:35], s61 offen lds
s_add_u32 m0, s60, s49
s_nop 0
buffer_load_dwordx4 v9, s[32:35], s61 offen lds
s_add_u32 m0, s60, s50
s_nop 0
buffer_load_dwordx4 v10, s[32:35], s61 offen lds
s_add_u32 m0, s60, s51
s_nop 0
buffer_load_dwordx4 v11, s[32:35], s61 offen lds
s_add_u32 m0, s60, s52
s_nop 0
buffer_load_dwordx4 v12, s[36:39], s62 offen lds
s_add_u32 m0, s60, s53
s_nop 0
buffer_load_dwordx4 v13, s[36:39], s62 offen lds
s_add_u32 m0, s60, s54
s_nop 0
buffer_load_dwordx4 v14, s[36:39], s62 offen lds
s_add_u32 m0, s60, s55
s_nop 0
buffer_load_dwordx4 v15, s[36:39], s62 offen lds
s_add_u32 m0, s60, s56
s_nop 0
buffer_load_dwordx4 v16, s[36:39], s62 offen lds
s_add_u32 m0, s60, s67
s_nop 0
buffer_load_dwordx4 v20, s[68:71], s66 offen lds
s_add_u32 m0, m0, 1024
s_nop 0
buffer_load_dwordx4 v21, s[68:71], s66 offen lds
s_add_u32 m0, m0, 1024
s_mov_b32 exec_hi, 0
buffer_load_dwordx4 v22, s[68:71], s66 offen lds
s_mov_b64 exec, -1
s_add_u32 s60, s60, 51200
s_cmp_eq_u32 s60, 153600
s_cselect_b32 s60, 0, s60
s_add_u32 s61, s61, 128
s_add_u32 s62, s62, 245760
s_add_u32 s66, s66, 245760
s_add_u32 s59, s59, 1
s_cmp_eq_u32 s59, 10
s_cselect_b32 s59, 0, s59
s_cselect_b32 s61, 0, s61
s_cselect_b32 s62, 0, s62
s_cselect_b32 s66, 0, s66
s_waitcnt vmcnt(12)
s_barrier
s_add_u32 m0, s60, s48
s_nop 0
buffer_load_dwordx4 v8, s[32:35], s61 offen lds
s_add_u32 m0, s60, s49
s_nop 0
buffer_load_dwordx4 v9, s[32:35], s61 offen lds
s_add_u32 m0, s60, s50
s_nop 0
buffer_load_dwordx4 v10, s[32:35], s61 offen lds
s_add_u32 m0, s60, s51
s_nop 0
buffer_load_dwordx4 v11, s[32:35], s61 offen lds
s_add_u32 m0, s60, s52
s_nop 0
buffer_load_dwordx4 v12, s[36:39], s62 offen lds
s_add_u32 m0, s60, s53
s_nop 0
buffer_load_dwordx4 v13, s[36:39], s62 offen lds
s_add_u32 m0, s60, s54
s_nop 0
buffer_load_dwordx4 v14, s[36:39], s62 offen lds
s_add_u32 m0, s60, s55
s_nop 0
buffer_load_dwordx4 v15, s[36:39], s62 offen lds
s_add_u32 m0, s60, s56
s_nop 0
buffer_load_dwordx4 v16, s[36:39], s62 offen lds
s_add_u32 m0, s60, s67
s_nop 0
buffer_load_dwordx4 v20, s[68:71], s66 offen lds
s_add_u32 m0, m0, 1024
s_nop 0
buffer_load_dwordx4 v21, s[68:71], s66 offen lds
s_add_u32 m0, m0, 1024
s_mov_b32 exec_hi, 0
buffer_load_dwordx4 v22, s[68:71], s66 offen lds
s_mov_b64 exec, -1
s_add_u32 s60, s60, 51200
s_cmp_eq_u32 s60, 153600
s_cselect_b32 s60, 0, s60
s_add_u32 s61, s61, 128
s_add_u32 s62, s62, 245760
s_add_u32 s66, s66, 245760
s_add_u32 s59, s59, 1
s_cmp_eq_u32 s59, 10
s_cselect_b32 s59, 0, s59
s_cselect_b32 s61, 0, s61
s_cselect_b32 s62, 0, s62
s_cselect_b32 s66, 0, s66
s_waitcnt vmcnt(12)
s_barrier
s_add_u32 m0, s60, s48
s_nop 0
buffer_load_dwordx4 v8, s[32:35], s61 offen lds
s_add_u32 m0, s60, s49
s_nop 0
buffer_load_dwordx4 v9, s[32:35], s61 offen lds
s_add_u32 m0, s60, s50
s_nop 0
buffer_load_dwordx4 v10, s[32:35], s61 offen lds
s_add_u32 m0, s60, s51
s_nop 0
buffer_load_dwordx4 v11, s[32:35], s61 offen lds
s_add_u32 m0, s60, s52
s_nop 0
buffer_load_dwordx4 v12, s[36:39], s62 offen lds
s_add_u32 m0, s60, s53
s_nop 0
buffer_load_dwordx4 v13, s[36:39], s62 offen lds
s_add_u32 m0, s60, s54
s_nop 0
buffer_load_dwordx4 v14, s[36:39], s62 offen lds
s_add_u32 m0, s60, s55
s_nop 0
buffer_load_dwordx4 v15, s[36:39], s62 offen lds
s_add_u32 m0, s60, s56
s_nop 0
buffer_load_dwordx4 v16, s[36:39], s62 offen lds
s_add_u32 m0, s60, s67
s_nop 0
buffer_load_dwordx4 v20, s[68:71], s66 offen lds
s_add_u32 m0, m0, 1024
s_nop 0
buffer_load_dwordx4 v21, s[68:71], s66 offen lds
s_add_u32 m0, m0, 1024
s_mov_b32 exec_hi, 0
buffer_load_dwordx4 v22, s[68:71], s66 offen lds
s_mov_b64 exec, -1
s_add_u32 s60, s60, 51200
s_cmp_eq_u32 s60, 153600
s_cselect_b32 s60, 0, s60
s_add_u32 s61, s61, 128
s_add_u32 s62, s62, 245760
s_add_u32 s66, s66, 245760
s_add_u32 s59, s59, 1
s_cmp_eq_u32 s59, 10
s_cselect_b32 s59, 0, s59
s_cselect_b32 s61, 0, s61
s_cselect_b32 s62, 0, s62
s_cselect_b32 s66, 0, s66
s_waitcnt vmcnt(12)
s_barrier
s_add_u32 m0, s60, s48
s_nop 0
buffer_load_dwordx4 v8, s[32:35], s61 offen lds
s_add_u32 m0, s60, s49
s_nop 0
buffer_load_dwordx4 v9, s[32:35], s61 offen lds
s_add_u32 m0, s60, s50
s_nop 0
buffer_load_dwordx4 v10, s[32:35], s61 offen lds
s_add_u32 m0, s60, s51
s_nop 0
buffer_load_dwordx4 v11, s[32:35], s61 offen lds
s_add_u32 m0, s60, s52
s_nop 0
buffer_load_dwordx4 v12, s[36:39], s62 offen lds
s_add_u32 m0, s60, s53
s_nop 0
buffer_load_dwordx4 v13, s[36:39], s62 offen lds
s_add_u32 m0, s60, s54
s_nop 0
buffer_load_dwordx4 v14, s[36:39], s62 offen lds
s_add_u32 m0, s60, s55
s_nop 0
buffer_load_dwordx4 v15, s[36:39], s62 offen lds
s_add_u32 m0, s60, s56
s_nop 0
buffer_load_dwordx4 v16, s[36:39], s62 offen lds
s_add_u32 m0, s60, s67
s_nop 0
buffer_load_dwordx4 v20, s[68:71], s66 offen lds
s_add_u32 m0, m0, 1024
s_nop 0
buffer_load_dwordx4 v21, s[68:71], s66 offen lds
s_add_u32 m0, m0, 1024
s_mov_b32 exec_hi, 0
buffer_load_dwordx4 v22, s[68:71], s66 offen lds
s_mov_b64 exec, -1
s_add_u32 s60, s60, 51200
s_cmp_eq_u32 s60, 153600
s_cselect_b32 s60, 0, s60
s_add_u32 s61, s61, 128
s_add_u32 s62, s62, 245760
s_add_u32 s66, s66, 245760
s_add_u32 s59, s59, 1
s_cmp_eq_u32 s59, 10
s_cselect_b32 s59, 0, s59
s_cselect_b32 s61, 0, s61
s_cselect_b32 s62, 0, s62
s_cselect_b32 s66, 0, s66
s_waitcnt vmcnt(12)
s_barrier
s_add_u32 m0, s60, s48
s_nop 0
buffer_load_dwordx4 v8, s[32:35], s61 offen lds
s_add_u32 m0, s60, s49
s_nop 0
buffer_load_dwordx4 v9, s[32:35], s61 offen lds
s_add_u32 m0, s60, s50
s_nop 0
buffer_load_dwordx4 v10, s[32:35], s61 offen lds
s_add_u32 m0, s60, s51
s_nop 0
buffer_load_dwordx4 v11, s[32:35], s61 offen lds
s_add_u32 m0, s60, s52
s_nop 0
buffer_load_dwordx4 v12, s[36:39], s62 offen lds
s_add_u32 m0, s60, s53
s_nop 0
buffer_load_dwordx4 v13, s[36:39], s62 offen lds
s_add_u32 m0, s60, s54
s_nop 0
buffer_load_dwordx4 v14, s[36:39], s62 offen lds
s_add_u32 m0, s60, s55
s_nop 0
buffer_load_dwordx4 v15, s[36:39], s62 offen lds
s_add_u32 m0, s60, s56
s_nop 0
buffer_load_dwordx4 v16, s[36:39], s62 offen lds
s_add_u32 m0, s60, s67
s_nop 0
buffer_load_dwordx4 v20, s[68:71], s66 offen lds
s_add_u32 m0, m0, 1024
s_nop 0
buffer_load_dwordx4 v21, s[68:71], s66 offen lds
s_add_u32 m0, m0, 1024
s_mov_b32 exec_hi, 0
buffer_load_dwordx4 v22, s[68:71], s66 offen lds
s_mov_b64 exec, -1
s_add_u32 s60, s60, 51200
s_cmp_eq_u32 s60, 153600
s_cselect_b32 s60, 0, s60
s_add_u32 s61, s61, 128
s_add_u32 s62, s62, 245760
s_add_u32 s66, s66, 245760
s_add_u32 s59, s59, 1
s_cmp_eq_u32 s59, 10
s_cselect_b32 s59, 0, s59
s_cselect_b32 s61, 0, s61
s_cselect_b32 s62, 0, s62
s_cselect_b32 s66, 0, s66
s_waitcnt vmcnt(12)
s_barrier
s_add_u32 m0, s60, s48
s_nop 0
buffer_load_dwordx4 v8, s[32:35], s61 offen lds
s_add_u32 m0, s60, s49
s_nop 0
buffer_load_dwordx4 v9, s[32:35], s61 offen lds
s_add_u32 m0, s60, s50
s_nop 0
buffer_load_dwordx4 v10, s[32:35], s61 offen lds
s_add_u32 m0, s60, s51
s_nop 0
buffer_load_dwordx4 v11, s[32:35], s61 offen lds
s_add_u32 m0, s60, s52
s_nop 0
buffer_load_dwordx4 v12, s[36:39], s62 offen lds
s_add_u32 m0, s60, s53
s_nop 0
buffer_load_dwordx4 v13, s[36:39], s62 offen lds
s_add_u32 m0, s60, s54
s_nop 0
buffer_load_dwordx4 v14, s[36:39], s62 offen lds
s_add_u32 m0, s60, s55
s_nop 0
buffer_load_dwordx4 v15, s[36:39], s62 offen lds
s_add_u32 m0, s60, s56
s_nop 0
buffer_load_dwordx4 v16, s[36:39], s62 offen lds
s_add_u32 m0, s60, s67
s_nop 0
buffer_load_dwordx4 v20, s[68:71], s66 offen lds
s_add_u32 m0, m0, 1024
s_nop 0
buffer_load_dwordx4 v21, s[68:71], s66 offen lds
s_add_u32 m0, m0, 1024
s_mov_b32 exec_hi, 0
buffer_load_dwordx4 v22, s[68:71], s66 offen lds
s_mov_b64 exec, -1
s_add_u32 s60, s60, 51200
s_cmp_eq_u32 s60, 153600
s_cselect_b32 s60, 0, s60
s_add_u32 s61, s61, 128
s_add_u32 s62, s62, 245760
s_add_u32 s66, s66, 245760
s_add_u32 s59, s59, 1
s_cmp_eq_u32 s59, 10
s_cselect_b32 s59, 0, s59
s_cselect_b32 s61, 0, s61
s_cselect_b32 s62, 0, s62
s_cselect_b32 s66, 0, s66
s_waitcnt vmcnt(12)
s_barrier
s_add_u32 m0, s60, s48
s_nop 0
buffer_load_dwordx4 v8, s[32:35], s61 offen lds
s_add_u32 m0, s60, s49
s_nop 0
buffer_load_dwordx4 v9, s[32:35], s61 offen lds
s_add_u32 m0, s60, s50
s_nop 0
buffer_load_dwordx4 v10, s[32:35], s61 offen lds
s_add_u32 m0, s60, s51
s_nop 0
buffer_load_dwordx4 v11, s[32:35], s61 offen lds
s_add_u32 m0, s60, s52
s_nop 0
buffer_load_dwordx4 v12, s[36:39], s62 offen lds
s_add_u32 m0, s60, s53
s_nop 0
buffer_load_dwordx4 v13, s[36:39], s62 offen lds
s_add_u32 m0, s60, s54
s_nop 0
buffer_load_dwordx4 v14, s[36:39], s62 offen lds
s_add_u32 m0, s60, s55
s_nop 0
buffer_load_dwordx4 v15, s[36:39], s62 offen lds
s_add_u32 m0, s60, s56
s_nop 0
buffer_load_dwordx4 v16, s[36:39], s62 offen lds
s_add_u32 m0, s60, s67
s_nop 0
buffer_load_dwordx4 v20, s[68:71], s66 offen lds
s_add_u32 m0, m0, 1024
s_nop 0
buffer_load_dwordx4 v21, s[68:71], s66 offen lds
s_add_u32 m0, m0, 1024
s_mov_b32 exec_hi, 0
buffer_load_dwordx4 v22, s[68:71], s66 offen lds
s_mov_b64 exec, -1
s_add_u32 s60, s60, 51200
s_cmp_eq_u32 s60, 153600
s_cselect_b32 s60, 0, s60
s_add_u32 s61, s61, 128
s_add_u32 s62, s62, 245760
s_add_u32 s66, s66, 245760
s_add_u32 s59, s59, 1
s_cmp_eq_u32 s59, 10
s_cselect_b32 s59, 0, s59
s_cselect_b32 s61, 0, s61
s_cselect_b32 s62, 0, s62
s_cselect_b32 s66, 0, s66
s_sub_u32 s3, s25, 1
s_cmp_lt_u32 s3, 2
s_cbranch_scc0 L_nz_1
s_lshl_b32 s58, s27, 11
s_lshl_b32 s44, s3, 10
s_add_u32 s58, s58, s44
s_add_u32 s58, s58, 15802368
s_add_u32 s100, s22, s58
s_addc_u32 s101, s23, 0
s_mov_b32 s47, 32768
L_pf_2:
s_mov_b32 s46, 0
s_load_dword s76, s[100:101], 0 glc
s_load_dword s77, s[100:101], 128 glc
s_load_dword s78, s[100:101], 256 glc
s_load_dword s79, s[100:101], 384 glc
s_waitcnt lgkmcnt(0)
s_xor_b32 s76, s76, s30
s_or_b32 s46, s46, s76
s_xor_b32 s77, s77, s30
s_or_b32 s46, s46, s77
s_xor_b32 s78, s78, s30
s_or_b32 s46, s46, s78
s_xor_b32 s79, s79, s30
s_or_b32 s46, s46, s79
s_load_dword s76, s[100:101], 512 glc
s_load_dword s77, s[100:101], 640 glc
s_load_dword s78, s[100:101], 768 glc
s_load_dword s79, s[100:101], 896 glc
s_waitcnt lgkmcnt(0)
s_xor_b32 s76, s76, s30
s_or_b32 s46, s46, s76
s_xor_b32 s77, s77, s30
s_or_b32 s46, s46, s77
s_xor_b32 s78, s78, s30
s_or_b32 s46, s46, s78
s_xor_b32 s79, s79, s30
s_or_b32 s46, s46, s79
s_cmp_eq_u32 s46, 0
s_cbranch_scc1 L_pfd_3
s_sleep 1
s_sub_u32 s47, s47, 1
s_cmp_lg_u32 s47, 0
s_cbranch_scc1 L_pf_2
L_pfd_3:
v_mov_b32 v2, 161536
v_mov_b32 v3, 1
s_mov_b64 exec, 1
ds_add_u32 v2, v3 offset:52
s_mov_b64 exec, -1
L_nz_1:
s_waitcnt vmcnt(12)
s_barrier
s_waitcnt vmcnt(0)
s_barrier
s_barrier
s_branch L_hp_post
L_helper_h:
s_mul_i32 s44, s26, 163840
s_add_u32 s32, s4, s44
s_addc_u32 s33, s5, 0
s_sub_u32 s34, 2621440, s44
s_mov_b32 s35, 0x20000
v_lshrrev_b32 v2, 3, v1
v_and_b32 v3, 7, v1
v_xor_b32 v4, v3, v2
v_lshlrev_b32 v4, 4, v4
s_lshl_b32 s44, s25, 5
v_add_u32 v5, s44, v2
v_mul_u32_u24 v5, 1280, v5
v_add_u32 v8, v5, v4
v_add_u32 v9, 10240, v8
v_add_u32 v10, 20480, v8
v_add_u32 v11, 30720, v8
s_lshl_b32 s48, s25, 12
s_add_u32 s49, s48, 1024
s_add_u32 s50, s48, 2048
s_add_u32 s51, s48, 3072
s_mov_b32 s60, 0
s_and_b32 s45, s27, 3
s_lshl_b32 s45, s45, 1
s_add_u32 s59, s45, s28
s_and_b32 s45, s26, 3
s_mul_i32 s45, s45, 3
s_add_u32 s59, s59, s45
s_cmp_ge_u32 s59, 10
s_cselect_b32 s45, 10, 0
s_sub_u32 s59, s59, s45
s_lshl_b32 s61, s59, 7
s_mul_i32 s62, s59, 196608
s_mul_i32 s66, s59, 245760
s_mov_b32 m0, s48
s_nop 0
buffer_load_dwordx4 v8, s[32:35], s61 offen lds
s_mov_b32 m0, s49
s_nop 0
buffer_load_dwordx4 v9, s[32:35], s61 offen lds
s_mov_b32 m0, s50
s_nop 0
buffer_load_dwordx4 v10, s[32:35], s61 offen lds
s_mov_b32 m0, s51
s_nop 0
buffer_load_dwordx4 v11, s[32:35], s61 offen lds
s_mul_i32 s44, s27, 384
s_add_u32 s36, s12, s44
s_addc_u32 s37, s13, 0
s_sub_u32 s38, 1966080, s44
s_mov_b32 s39, 0x20000
v_add_u32 v2, 0, v1
v_mul_u32_u24 v3, 2731, v2
v_lshrrev_b32 v3, 16, v3
v_mul_u32_u24 v4, 24, v3
v_sub_u32 v4, v2, v4
v_and_b32 v5, 6, v3
v_xor_b32 v4, v4, v5
v_lshrrev_b32 v5, 2, v3
v_lshlrev_b32 v5, 3, v5
v_and_b32 v6, 3, v3
v_add_u32 v5, v5, v6
s_lshl_b32 s44, s25, 4
s_add_u32 s44, s44, 0
v_add_u32 v5, s44, v5
v_mul_u32_u24 v5, 3072, v5
v_lshl_add_u32 v12, v4, 4, v5
s_mul_i32 s44, s25, 6144
s_add_u32 s52, s44, 16384
s_mov_b32 m0, s52
s_nop 0
buffer_load_dwordx4 v12, s[36:39], s62 offen lds
v_add_u32 v2, 64, v1
v_mul_u32_u24 v3, 2731, v2
v_lshrrev_b32 v3, 16, v3
v_mul_u32_u24 v4, 24, v3
v_sub_u32 v4, v2, v4
v_and_b32 v5, 6, v3
v_xor_b32 v4, v4, v5
v_lshrrev_b32 v5, 2, v3
v_lshlrev_b32 v5, 3, v5
v_and_b32 v6, 3, v3
v_add_u32 v5, v5, v6
s_lshl_b32 s44, s25, 4
s_add_u32 s44, s44, 0
v_add_u32 v5, s44, v5
v_mul_u32_u24 v5, 3072, v5
v_lshl_add_u32 v13, v4, 4, v5
s_mul_i32 s44, s25, 6144
s_add_u32 s53, s44, 17408
s_mov_b32 m0, s53
s_nop 0
buffer_load_dwordx4 v13, s[36:39], s62 offen lds
v_add_u32 v2, 128, v1
v_mul_u32_u24 v3, 2731, v2
v_lshrrev_b32 v3, 16, v3
v_mul_u32_u24 v4, 24, v3
v_sub_u32 v4, v2, v4
v_and_b32 v5, 6, v3
v_xor_b32 v4, v4, v5
v_lshrrev_b32 v5, 2, v3
v_lshlrev_b32 v5, 3, v5
v_and_b32 v6, 3, v3
v_add_u32 v5, v5, v6
s_lshl_b32 s44, s25, 4
s_add_u32 s44, s44, 0
v_add_u32 v5, s44, v5
v_mul_u32_u24 v5, 3072, v5
v_lshl_add_u32 v14, v4, 4, v5
s_mul_i32 s44, s25, 6144
s_add_u32 s54, s44, 18432
s_mov_b32 m0, s54
s_nop 0
buffer_load_dwordx4 v14, s[36:39], s62 offen lds
v_add_u32 v2, 0, v1
v_mul_u32_u24 v3, 2731, v2
v_lshrrev_b32 v3, 16, v3
v_mul_u32_u24 v4, 24, v3
v_sub_u32 v4, v2, v4
v_and_b32 v5, 6, v3
v_xor_b32 v4, v4, v5
v_lshrrev_b32 v5, 2, v3
v_lshlrev_b32 v5, 3, v5
v_and_b32 v6, 3, v3
v_add_u32 v5, v5, v6
s_lshl_b32 s44, s25, 4
s_add_u32 s44, s44, 4
v_add_u32 v5, s44, v5
v_mul_u32_u24 v5, 3072, v5
v_lshl_add_u32 v15, v4, 4, v5
s_mul_i32 s44, s25, 6144
s_add_u32 s55, s44, 19456
s_mov_b32 m0, s55
s_nop 0
buffer_load_dwordx4 v15, s[36:39], s62 offen lds
v_add_u32 v2, 64, v1
v_mul_u32_u24 v3, 2731, v2
v_lshrrev_b32 v3, 16, v3
v_mul_u32_u24 v4, 24, v3
v_sub_u32 v4, v2, v4
v_and_b32 v5, 6, v3
v_xor_b32 v4, v4, v5
v_lshrrev_b32 v5, 2, v3
v_lshlrev_b32 v5, 3, v5
v_and_b32 v6, 3, v3
v_add_u32 v5, v5, v6
s_lshl_b32 s44, s25, 4
s_add_u32 s44, s44, 4
v_add_u32 v5, s44, v5
v_mul_u32_u24 v5, 3072, v5
v_lshl_add_u32 v16, v4, 4, v5
s_mul_i32 s44, s25, 6144
s_add_u32 s56, s44, 20480
s_mov_b32 m0, s56
s_nop 0
buffer_load_dwordx4 v16, s[36:39], s62 offen lds
v_add_u32 v2, 128, v1
v_mul_u32_u24 v3, 2731, v2
v_lshrrev_b32 v3, 16, v3
v_mul_u32_u24 v4, 24, v3
v_sub_u32 v4, v2, v4
v_and_b32 v5, 6, v3
v_xor_b32 v4, v4, v5
v_lshrrev_b32 v5, 2, v3
v_lshlrev_b32 v5, 3, v5
v_and_b32 v6, 3, v3
v_add_u32 v5, v5, v6
s_lshl_b32 s44, s25, 4
s_add_u32 s44, s44, 4
v_add_u32 v5, s44, v5
v_mul_u32_u24 v5, 3072, v5
v_lshl_add_u32 v17, v4, 4, v5
s_mul_i32 s44, s25, 6144
s_add_u32 s57, s44, 21504
s_mov_b32 m0, s57
s_nop 0
buffer_load_dwordx4 v17, s[36:39], s62 offen lds
s_mov_b32 s96, s16
s_mov_b32 s97, s17
s_movk_i32 s98, 1280
s_mov_b32 s99, 0x20000
v_lshlrev_b32 v2, 4, v1
s_mov_b32 m0, 159744
s_nop 0
buffer_load_dwordx4 v2, s[96:99], 0 offen lds
s_mov_b32 exec_lo, 0xffff
s_mov_b32 exec_hi, 0
buffer_load_dwordx4 v2, s[96:99], 0 offen offset:1024 lds
s_mov_b64 exec, -1
s_add_u32 s60, s60, 51200
s_cmp_eq_u32 s60, 153600
s_cselect_b32 s60, 0, s60
s_add_u32 s61, s61, 128
s_add_u32 s62, s62, 196608
s_add_u32 s66, s66, 245760
s_add_u32 s59, s59, 1
s_cmp_eq_u32 s59, 10
s_cselect_b32 s59, 0, s59
s_cselect_b32 s61, 0, s61
s_cselect_b32 s62, 0, s62
s_cselect_b32 s66, 0, s66
s_waitcnt vmcnt(0)
s_barrier
s_add_u32 m0, s60, s48
s_nop 0
buffer_load_dwordx4 v8, s[32:35], s61 offen lds
s_add_u32 m0, s60, s49
s_nop 0
buffer_load_dwordx4 v9, s[32:35], s61 offen lds
s_add_u32 m0, s60, s50
s_nop 0
buffer_load_dwordx4 v10, s[32:35], s61 offen lds
s_add_u32 m0, s60, s51
s_nop 0
buffer_load_dwordx4 v11, s[32:35], s61 offen lds
s_add_u32 m0, s60, s52
s_nop 0
buffer_load_dwordx4 v12, s[36:39], s62 offen lds
s_add_u32 m0, s60, s53
s_nop 0
buffer_load_dwordx4 v13, s[36:39], s62 offen lds
s_add_u32 m0, s60, s54
s_nop 0
buffer_load_dwordx4 v14, s[36:39], s62 offen lds
s_add_u32 m0, s60, s55
s_nop 0
buffer_load_dwordx4 v15, s[36:39], s62 offen lds
s_add_u32 m0, s60, s56
s_nop 0
buffer_load_dwordx4 v16, s[36:39], s62 offen lds
s_add_u32 m0, s60, s57
s_nop 0
buffer_load_dwordx4 v17, s[36:39], s62 offen lds
s_add_u32 s60, s60, 51200
s_cmp_eq_u32 s60, 153600
s_cselect_b32 s60, 0, s60
s_add_u32 s61, s61, 128
s_add_u32 s62, s62, 196608
s_add_u32 s66, s66, 245760
s_add_u32 s59, s59, 1
s_cmp_eq_u32 s59, 10
s_cselect_b32 s59, 0, s59
s_cselect_b32 s61, 0, s61
s_cselect_b32 s62, 0, s62
s_cselect_b32 s66, 0, s66
s_add_u32 m0, s60, s48
s_nop 0
buffer_load_dwordx4 v8, s[32:35], s61 offen lds
s_add_u32 m0, s60, s49
s_nop 0
buffer_load_dwordx4 v9, s[32:35], s61 offen lds
s_add_u32 m0, s60, s50
s_nop 0
buffer_load_dwordx4 v10, s[32:35], s61 offen lds
s_add_u32 m0, s60, s51
s_nop 0
buffer_load_dwordx4 v11, s[32:35], s61 offen lds
s_add_u32 m0, s60, s52
s_nop 0
buffer_load_dwordx4 v12, s[36:39], s62 offen lds
s_add_u32 m0, s60, s53
s_nop 0
buffer_load_dwordx4 v13, s[36:39], s62 offen lds
s_add_u32 m0, s60, s54
s_nop 0
buffer_load_dwordx4 v14, s[36:39], s62 offen lds
s_add_u32 m0, s60, s55
s_nop 0
buffer_load_dwordx4 v15, s[36:39], s62 offen lds
s_add_u32 m0, s60, s56
s_nop 0
buffer_load_dwordx4 v16, s[36:39], s62 offen lds
s_add_u32 m0, s60, s57
s_nop 0
buffer_load_dwordx4 v17, s[36:39], s62 offen lds
s_add_u32 s60, s60, 51200
s_cmp_eq_u32 s60, 153600
s_cselect_b32 s60, 0, s60
s_add_u32 s61, s61, 128
s_add_u32 s62, s62, 196608
s_add_u32 s66, s66, 245760
s_add_u32 s59, s59, 1
s_cmp_eq_u32 s59, 10
s_cselect_b32 s59, 0, s59
s_cselect_b32 s61, 0, s61
s_cselect_b32 s62, 0, s62
s_cselect_b32 s66, 0, s66
v_mov_b32 v2, 161536
ds_read_b32 v3, v2 offset:0
s_waitcnt lgkmcnt(0)
v_readfirstlane_b32 s30, v3
s_waitcnt vmcnt(10)
s_barrier
s_add_u32 m0, s60, s48
s_nop 0
buffer_load_dwordx4 v8, s[32:35], s61 offen lds
s_add_u32 m0, s60, s49
s_nop 0
buffer_load_dwordx4 v9, s[32:35], s61 offen lds
s_add_u32 m0, s60, s50
s_nop 0
buffer_load_dwordx4 v10, s[32:35], s61 offen lds
s_add_u32 m0, s60, s51
s_nop 0
buffer_load_dwordx4 v11, s[32:35], s61 offen lds
s_add_u32 m0, s60, s52
s_nop 0
buffer_load_dwordx4 v12, s[36:39], s62 offen lds
s_add_u32 m0, s60, s53
s_nop 0
buffer_load_dwordx4 v13, s[36:39], s62 offen lds
s_add_u32 m0, s60, s54
s_nop 0
buffer_load_dwordx4 v14, s[36:39], s62 offen lds
s_add_u32 m0, s60, s55
s_nop 0
buffer_load_dwordx4 v15, s[36:39], s62 offen lds
s_add_u32 m0, s60, s56
s_nop 0
buffer_load_dwordx4 v16, s[36:39], s62 offen lds
s_add_u32 m0, s60, s57
s_nop 0
buffer_load_dwordx4 v17, s[36:39], s62 offen lds
s_add_u32 s60, s60, 51200
s_cmp_eq_u32 s60, 153600
s_cselect_b32 s60, 0, s60
s_add_u32 s61, s61, 128
s_add_u32 s62, s62, 196608
s_add_u32 s66, s66, 245760
s_add_u32 s59, s59, 1
s_cmp_eq_u32 s59, 10
s_cselect_b32 s59, 0, s59
s_cselect_b32 s61, 0, s61
s_cselect_b32 s62, 0, s62
s_cselect_b32 s66, 0, s66
s_lshl_b32 s44, s27, 13
s_lshl_b32 s45, s26, 9
s_add_u32 s44, s44, s45
s_add_u32 s44, s44, 14680064
s_cmp_eq_u32 s25, 0
s_cselect_b32 s44, s44, 2147483648
v_and_b32 v2, 31, v1
v_lshlrev_b32 v2, 4, v2
v_add_u32 v2, s44, v2
v_mov_b32 v32, 0
v_mov_b32 v33, 0
v_mov_b32 v34, 0
v_mov_b32 v35, 0
s_mov_b32 exec_hi, 0
buffer_store_dwordx4 v[32:35], v2, s[40:43], 0 offen sc1
s_mov_b64 exec, -1
s_waitcnt vmcnt(11)
s_barrier
s_add_u32 m0, s60, s48
s_nop 0
buffer_load_dwordx4 v8, s[32:35], s61 offen lds
s_add_u32 m0, s60, s49
s_nop 0
buffer_load_dwordx4 v9, s[32:35], s61 offen lds
s_add_u32 m0, s60, s50
s_nop 0
buffer_load_dwordx4 v10, s[32:35], s61 offen lds
s_add_u32 m0, s60, s51
s_nop 0
buffer_load_dwordx4 v11, s[32:35], s61 offen lds
s_add_u32 m0, s60, s52
s_nop 0
buffer_load_dwordx4 v12, s[36:39], s62 offen lds
s_add_u32 m0, s60, s53
s_nop 0
buffer_load_dwordx4 v13, s[36:39], s62 offen lds
s_add_u32 m0, s60, s54
s_nop 0
buffer_load_dwordx4 v14, s[36:39], s62 offen lds
s_add_u32 m0, s60, s55
s_nop 0
buffer_load_dwordx4 v15, s[36:39], s62 offen lds
s_add_u32 m0, s60, s56
s_nop 0
buffer_load_dwordx4 v16, s[36:39], s62 offen lds
s_add_u32 m0, s60, s57
s_nop 0
buffer_load_dwordx4 v17, s[36:39], s62 offen lds
s_add_u32 s60, s60, 51200
s_cmp_eq_u32 s60, 153600
s_cselect_b32 s60, 0, s60
s_add_u32 s61, s61, 128
s_add_u32 s62, s62, 196608
s_add_u32 s66, s66, 245760
s_add_u32 s59, s59, 1
s_cmp_eq_u32 s59, 10
s_cselect_b32 s59, 0, s59
s_cselect_b32 s61, 0, s61
s_cselect_b32 s62, 0, s62
s_cselect_b32 s66, 0, s66
s_and_b32 s44, s2, 7
s_lshl_b32 s44, s44, 4
s_lshr_b32 s45, s31, 1
s_add_u32 s64, s44, s45
s_lshl_b32 s44, s25, 7
s_add_u32 s64, s64, s44
s_mul_i32 s70, s64, 964
s_lshr_b32 s70, s70, 16
s_mul_i32 s44, s70, 68
s_sub_u32 s71, s64, s44
s_mul_i32 s68, s25, 51200
s_add_u32 s68, s68, 40960
s_cmp_eq_u32 s25, 3
s_cselect_b32 s68, 153600, s68
s_cselect_b32 s67, 0, 1024
s_lshl_b32 s44, s70, 12
s_lshr_b32 s45, s71, 2
s_lshl_b32 s45, s45, 7
s_add_u32 s44, s44, s45
s_and_b32 s45, s71, 3
s_lshl_b32 s45, s45, 2
s_add_u32 s44, s44, s45
s_add_u32 s65, s44, 15826944
s_cmp_ge_u32 s64, 272
s_cselect_b32 s65, 2147483648, s65
v_add_u32 v2, 0, v1
v_mul_u32_u24 v3, 3277, v2
v_lshrrev_b32 v32, 16, v3
v_mul_u32_u24 v4, 20, v32
v_sub_u32 v4, v2, v4
v_lshlrev_b32 v44, 4, v4
v_add_u32 v2, 64, v1
v_mul_u32_u24 v3, 3277, v2
v_lshrrev_b32 v33, 16, v3
v_mul_u32_u24 v4, 20, v33
v_sub_u32 v4, v2, v4
v_lshlrev_b32 v45, 4, v4
v_add_u32 v2, 128, v1
v_mul_u32_u24 v3, 3277, v2
v_lshrrev_b32 v34, 16, v3
v_mul_u32_u24 v4, 20, v34
v_sub_u32 v4, v2, v4
v_lshlrev_b32 v46, 4, v4
v_add_u32 v2, 192, v1
v_mul_u32_u24 v3, 3277, v2
v_lshrrev_b32 v35, 16, v3
v_mul_u32_u24 v4, 20, v35
v_sub_u32 v4, v2, v4
v_lshlrev_b32 v47, 4, v4
v_add_u32 v2, 256, v1
v_mul_u32_u24 v3, 3277, v2
v_lshrrev_b32 v36, 16, v3
v_mul_u32_u24 v4, 20, v36
v_sub_u32 v4, v2, v4
v_lshlrev_b32 v48, 4, v4
v_add_u32 v2, 320, v1
v_mul_u32_u24 v3, 3277, v2
v_lshrrev_b32 v37, 16, v3
v_mul_u32_u24 v4, 20, v37
v_sub_u32 v4, v2, v4
v_lshlrev_b32 v49, 4, v4
v_add_u32 v2, 384, v1
v_mul_u32_u24 v3, 3277, v2
v_lshrrev_b32 v38, 16, v3
v_mul_u32_u24 v4, 20, v38
v_sub_u32 v4, v2, v4
v_lshlrev_b32 v50, 4, v4
v_add_u32 v2, 448, v1
v_mul_u32_u24 v3, 3277, v2
v_lshrrev_b32 v39, 16, v3
v_mul_u32_u24 v4, 20, v39
v_sub_u32 v4, v2, v4
v_lshlrev_b32 v51, 4, v4
v_add_u32 v2, 512, v1
v_mul_u32_u24 v3, 3277, v2
v_lshrrev_b32 v40, 16, v3
v_mul_u32_u24 v4, 20, v40
v_sub_u32 v4, v2, v4
v_lshlrev_b32 v52, 4, v4
v_add_u32 v2, 576, v1
v_mul_u32_u24 v3, 3277, v2
v_lshrrev_b32 v41, 16, v3
v_mul_u32_u24 v4, 20, v41
v_sub_u32 v4, v2, v4
v_lshlrev_b32 v53, 4, v4
s_cmp_lt_u32 s71, 48
s_cselect_b32 s96, s14, s8
s_cselect_b32 s97, s15, s9
s_mov_b32 s98, 819200
s_cselect_b32 s98, 1966080, s98
s_cbranch_scc0 L_jr_4
s_lshl_b32 s44, s71, 5
v_add_u32 v32, s44, v32
v_add_u32 v33, s44, v33
v_add_u32 v34, s44, v34
v_add_u32 v35, s44, v35
v_add_u32 v36, s44, v36
v_add_u32 v37, s44, v37
v_add_u32 v38, s44, v38
v_add_u32 v39, s44, v39
v_add_u32 v40, s44, v40
v_add_u32 v41, s44, v41
s_branch L_jr_6
L_jr_4:
s_cmp_lt_u32 s71, 64
s_cbranch_scc0 L_jr_5
s_sub_u32 s44, s71, 48
s_mul_i32 s44, s44, 40
v_lshrrev_b32 v2, 4, v32
v_mul_u32_u24 v2, 20, v2
v_and_b32 v3, 15, v32
v_add3_u32 v32, v2, v3, s44
v_lshrrev_b32 v2, 4, v33
v_mul_u32_u24 v2, 20, v2
v_and_b32 v3, 15, v33
v_add3_u32 v33, v2, v3, s44
v_lshrrev_b32 v2, 4, v34
v_mul_u32_u24 v2, 20, v2
v_and_b32 v3, 15, v34
v_add3_u32 v34, v2, v3, s44
v_lshrrev_b32 v2, 4, v35
v_mul_u32_u24 v2, 20, v2
v_and_b32 v3, 15, v35
v_add3_u32 v35, v2, v3, s44
v_lshrrev_b32 v2, 4, v36
v_mul_u32_u24 v2, 20, v2
v_and_b32 v3, 15, v36
v_add3_u32 v36, v2, v3, s44
v_lshrrev_b32 v2, 4, v37
v_mul_u32_u24 v2, 20, v2
v_and_b32 v3, 15, v37
v_add3_u32 v37, v2, v3, s44
v_lshrrev_b32 v2, 4, v38
v_mul_u32_u24 v2, 20, v2
v_and_b32 v3, 15, v38
v_add3_u32 v38, v2, v3, s44
v_lshrrev_b32 v2, 4, v39
v_mul_u32_u24 v2, 20, v2
v_and_b32 v3, 15, v39
v_add3_u32 v39, v2, v3, s44
v_lshrrev_b32 v2, 4, v40
v_mul_u32_u24 v2, 20, v2
v_and_b32 v3, 15, v40
v_add3_u32 v40, v2, v3, s44
v_lshrrev_b32 v2, 4, v41
v_mul_u32_u24 v2, 20, v2
v_and_b32 v3, 15, v41
v_add3_u32 v41, v2, v3, s44
s_branch L_jr_6
L_jr_5:
s_sub_u32 s44, s71, 64
s_lshl_b32 s44, s44, 3
v_lshrrev_b32 v2, 4, v32
v_lshlrev_b32 v2, 2, v2
v_bfe_u32 v3, v32, 2, 2
v_add_u32 v3, 2, v3
v_and_b32 v3, 3, v3
v_add3_u32 v2, v2, v3, s44
v_mul_u32_u24 v2, 20, v2
v_and_b32 v3, 3, v32
v_add3_u32 v32, v2, v3, 16
v_lshrrev_b32 v2, 4, v33
v_lshlrev_b32 v2, 2, v2
v_bfe_u32 v3, v33, 2, 2
v_add_u32 v3, 2, v3
v_and_b32 v3, 3, v3
v_add3_u32 v2, v2, v3, s44
v_mul_u32_u24 v2, 20, v2
v_and_b32 v3, 3, v33
v_add3_u32 v33, v2, v3, 16
v_lshrrev_b32 v2, 4, v34
v_lshlrev_b32 v2, 2, v2
v_bfe_u32 v3, v34, 2, 2
v_add_u32 v3, 2, v3
v_and_b32 v3, 3, v3
v_add3_u32 v2, v2, v3, s44
v_mul_u32_u24 v2, 20, v2
v_and_b32 v3, 3, v34
v_add3_u32 v34, v2, v3, 16
v_lshrrev_b32 v2, 4, v35
v_lshlrev_b32 v2, 2, v2
v_bfe_u32 v3, v35, 2, 2
v_add_u32 v3, 2, v3
v_and_b32 v3, 3, v3
v_add3_u32 v2, v2, v3, s44
v_mul_u32_u24 v2, 20, v2
v_and_b32 v3, 3, v35
v_add3_u32 v35, v2, v3, 16
v_lshrrev_b32 v2, 4, v36
v_lshlrev_b32 v2, 2, v2
v_bfe_u32 v3, v36, 2, 2
v_add_u32 v3, 2, v3
v_and_b32 v3, 3, v3
v_add3_u32 v2, v2, v3, s44
v_mul_u32_u24 v2, 20, v2
v_and_b32 v3, 3, v36
v_add3_u32 v36, v2, v3, 16
v_lshrrev_b32 v2, 4, v37
v_lshlrev_b32 v2, 2, v2
v_bfe_u32 v3, v37, 2, 2
v_add_u32 v3, 2, v3
v_and_b32 v3, 3, v3
v_add3_u32 v2, v2, v3, s44
v_mul_u32_u24 v2, 20, v2
v_and_b32 v3, 3, v37
v_add3_u32 v37, v2, v3, 16
v_lshrrev_b32 v2, 4, v38
v_lshlrev_b32 v2, 2, v2
v_bfe_u32 v3, v38, 2, 2
v_add_u32 v3, 2, v3
v_and_b32 v3, 3, v3
v_add3_u32 v2, v2, v3, s44
v_mul_u32_u24 v2, 20, v2
v_and_b32 v3, 3, v38
v_add3_u32 v38, v2, v3, 16
v_lshrrev_b32 v2, 4, v39
v_lshlrev_b32 v2, 2, v2
v_bfe_u32 v3, v39, 2, 2
v_add_u32 v3, 2, v3
v_and_b32 v3, 3, v3
v_add3_u32 v2, v2, v3, s44
v_mul_u32_u24 v2, 20, v2
v_and_b32 v3, 3, v39
v_add3_u32 v39, v2, v3, 16
v_lshrrev_b32 v2, 4, v40
v_lshlrev_b32 v2, 2, v2
v_bfe_u32 v3, v40, 2, 2
v_add_u32 v3, 2, v3
v_and_b32 v3, 3, v3
v_add3_u32 v2, v2, v3, s44
v_mul_u32_u24 v2, 20, v2
v_and_b32 v3, 3, v40
v_add3_u32 v40, v2, v3, 16
v_lshrrev_b32 v2, 4, v41
v_lshlrev_b32 v2, 2, v2
v_bfe_u32 v3, v41, 2, 2
v_add_u32 v3, 2, v3
v_and_b32 v3, 3, v3
v_add3_u32 v2, v2, v3, s44
v_mul_u32_u24 v2, 20, v2
v_and_b32 v3, 3, v41
v_add3_u32 v41, v2, v3, 16
L_jr_6:
s_mov_b32 s99, 0x20000
s_mul_i32 s44, s70, 320
s_cmp_ge_u32 s64, 272
s_cselect_b32 s44, 2147483648, s44
v_mul_u32_u24 v2, 1280, v32
v_add3_u32 v32, v2, v44, s44
v_mul_u32_u24 v2, 1280, v33
v_add3_u32 v33, v2, v45, s44
v_mul_u32_u24 v2, 1280, v34
v_add3_u32 v34, v2, v46, s44
v_mul_u32_u24 v2, 1280, v35
v_add3_u32 v35, v2, v47, s44
v_mul_u32_u24 v2, 1280, v36
v_add3_u32 v36, v2, v48, s44
v_mul_u32_u24 v2, 1280, v37
v_add3_u32 v37, v2, v49, s44
v_mul_u32_u24 v2, 1280, v38
v_add3_u32 v38, v2, v50, s44
v_mul_u32_u24 v2, 1280, v39
v_add3_u32 v39, v2, v51, s44
v_mul_u32_u24 v2, 1280, v40
v_add3_u32 v40, v2, v52, s44
v_mul_u32_u24 v2, 1280, v41
v_add3_u32 v41, v2, v53, s44
s_mov_b32 s44, s68
s_mov_b32 m0, s44
s_nop 0
buffer_load_dwordx4 v32, s[96:99], 0 offen lds
s_add_u32 s44, s44, s67
s_mov_b32 m0, s44
s_nop 0
buffer_load_dwordx4 v33, s[96:99], 0 offen lds
s_add_u32 s44, s44, s67
s_mov_b32 m0, s44
s_nop 0
buffer_load_dwordx4 v34, s[96:99], 0 offen lds
s_add_u32 s44, s44, s67
s_mov_b32 m0, s44
s_nop 0
buffer_load_dwordx4 v35, s[96:99], 0 offen lds
s_add_u32 s44, s44, s67
s_mov_b32 m0, s44
s_nop 0
buffer_load_dwordx4 v36, s[96:99], 0 offen lds
s_add_u32 s44, s44, s67
s_mov_b32 m0, s44
s_nop 0
buffer_load_dwordx4 v37, s[96:99], 0 offen lds
s_add_u32 s44, s44, s67
s_mov_b32 m0, s44
s_nop 0
buffer_load_dwordx4 v38, s[96:99], 0 offen lds
s_add_u32 s44, s44, s67
s_mov_b32 m0, s44
s_nop 0
buffer_load_dwordx4 v39, s[96:99], 0 offen lds
s_add_u32 s44, s44, s67
s_mov_b32 m0, s44
s_nop 0
buffer_load_dwordx4 v40, s[96:99], 0 offen lds
s_add_u32 s44, s44, s67
s_mov_b32 m0, s44
s_nop 0
buffer_load_dwordx4 v41, s[96:99], 0 offen lds
s_add_u32 s44, s44, s67
s_waitcnt vmcnt(21)
s_barrier
s_add_u32 m0, s60, s48
s_nop 0
buffer_load_dwordx4 v8, s[32:35], s61 offen lds
s_add_u32 m0, s60, s49
s_nop 0
buffer_load_dwordx4 v9, s[32:35], s61 offen lds
s_add_u32 m0, s60, s50
s_nop 0
buffer_load_dwordx4 v10, s[32:35], s61 offen lds
s_add_u32 m0, s60, s51
s_nop 0
buffer_load_dwordx4 v11, s[32:35], s61 offen lds
s_add_u32 m0, s60, s52
s_nop 0
buffer_load_dwordx4 v12, s[36:39], s62 offen lds
s_add_u32 m0, s60, s53
s_nop 0
buffer_load_dwordx4 v13, s[36:39], s62 offen lds
s_add_u32 m0, s60, s54
s_nop 0
buffer_load_dwordx4 v14, s[36:39], s62 offen lds
s_add_u32 m0, s60, s55
s_nop 0
buffer_load_dwordx4 v15, s[36:39], s62 offen lds
s_add_u32 m0, s60, s56
s_nop 0
buffer_load_dwordx4 v16, s[36:39], s62 offen lds
s_add_u32 m0, s60, s57
s_nop 0
buffer_load_dwordx4 v17, s[36:39], s62 offen lds
s_add_u32 s60, s60, 51200
s_cmp_eq_u32 s60, 153600
s_cselect_b32 s60, 0, s60
s_add_u32 s61, s61, 128
s_add_u32 s62, s62, 196608
s_add_u32 s66, s66, 245760
s_add_u32 s59, s59, 1
s_cmp_eq_u32 s59, 10
s_cselect_b32 s59, 0, s59
s_cselect_b32 s61, 0, s61
s_cselect_b32 s62, 0, s62
s_cselect_b32 s66, 0, s66
s_waitcnt vmcnt(20)
s_barrier
s_add_u32 m0, s60, s48
s_nop 0
buffer_load_dwordx4 v8, s[32:35], s61 offen lds
s_add_u32 m0, s60, s49
s_nop 0
buffer_load_dwordx4 v9, s[32:35], s61 offen lds
s_add_u32 m0, s60, s50
s_nop 0
buffer_load_dwordx4 v10, s[32:35], s61 offen lds
s_add_u32 m0, s60, s51
s_nop 0
buffer_load_dwordx4 v11, s[32:35], s61 offen lds
s_add_u32 m0, s60, s52
s_nop 0
buffer_load_dwordx4 v12, s[36:39], s62 offen lds
s_add_u32 m0, s60, s53
s_nop 0
buffer_load_dwordx4 v13, s[36:39], s62 offen lds
s_add_u32 m0, s60, s54
s_nop 0
buffer_load_dwordx4 v14, s[36:39], s62 offen lds
s_add_u32 m0, s60, s55
s_nop 0
buffer_load_dwordx4 v15, s[36:39], s62 offen lds
s_add_u32 m0, s60, s56
s_nop 0
buffer_load_dwordx4 v16, s[36:39], s62 offen lds
s_add_u32 m0, s60, s57
s_nop 0
buffer_load_dwordx4 v17, s[36:39], s62 offen lds
s_add_u32 s60, s60, 51200
s_cmp_eq_u32 s60, 153600
s_cselect_b32 s60, 0, s60
s_add_u32 s61, s61, 128
s_add_u32 s62, s62, 196608
s_add_u32 s66, s66, 245760
s_add_u32 s59, s59, 1
s_cmp_eq_u32 s59, 10
s_cselect_b32 s59, 0, s59
s_cselect_b32 s61, 0, s61
s_cselect_b32 s62, 0, s62
s_cselect_b32 s66, 0, s66
s_lshl_b32 s44, s27, 11
s_lshl_b32 s45, s26, 7
s_add_u32 s44, s44, s45
s_add_u32 s58, s44, 15802368
s_cmp_eq_u32 s25, 0
s_cselect_b32 s58, s58, 2147483648
v_mov_b32 v2, s58
v_mov_b32 v3, s30
s_mov_b64 exec, 1
buffer_store_dword v3, v2, s[40:43], 0 offen sc1
s_mov_b64 exec, -1
s_waitcnt vmcnt(11)
s_barrier
s_add_u32 m0, s60, s48
s_nop 0
buffer_load_dwordx4 v8, s[32:35], s61 offen lds
s_add_u32 m0, s60, s49
s_nop 0
buffer_load_dwordx4 v9, s[32:35], s61 offen lds
s_add_u32 m0, s60, s50
s_nop 0
buffer_load_dwordx4 v10, s[32:35], s61 offen lds
s_add_u32 m0, s60, s51
s_nop 0
buffer_load_dwordx4 v11, s[32:35], s61 offen lds
s_add_u32 m0, s60, s52
s_nop 0
buffer_load_dwordx4 v12, s[36:39], s62 offen lds
s_add_u32 m0, s60, s53
s_nop 0
buffer_load_dwordx4 v13, s[36:39], s62 offen lds
s_add_u32 m0, s60, s54
s_nop 0
buffer_load_dwordx4 v14, s[36:39], s62 offen lds
s_add_u32 m0, s60, s55
s_nop 0
buffer_load_dwordx4 v15, s[36:39], s62 offen lds
s_add_u32 m0, s60, s56
s_nop 0
buffer_load_dwordx4 v16, s[36:39], s62 offen lds
s_add_u32 m0, s60, s57
s_nop 0
buffer_load_dwordx4 v17, s[36:39], s62 offen lds
s_add_u32 s60, s60, 51200
s_cmp_eq_u32 s60, 153600
s_cselect_b32 s60, 0, s60
s_add_u32 s61, s61, 128
s_add_u32 s62, s62, 196608
s_add_u32 s66, s66, 245760
s_add_u32 s59, s59, 1
s_cmp_eq_u32 s59, 10
s_cselect_b32 s59, 0, s59
s_cselect_b32 s61, 0, s61
s_cselect_b32 s62, 0, s62
s_cselect_b32 s66, 0, s66
v_lshrrev_b32 v2, 4, v1
v_bfe_u32 v3, v1, 2, 2
v_and_b32 v4, 3, v1
v_lshl_add_u32 v5, v2, 2, v3
v_mul_u32_u24 v5, 320, v5
v_mul_u32_u24 v6, 40, v4
v_add3_u32 v5, v5, v6, s68
ds_read_b64_tr_b16 v[32:33], v5 offset:0
ds_read_b64_tr_b16 v[34:35], v5 offset:5120
ds_read_b64_tr_b16 v[36:37], v5 offset:8
ds_read_b64_tr_b16 v[38:39], v5 offset:5128
ds_read_b64_tr_b16 v[40:41], v5 offset:16
ds_read_b64_tr_b16 v[42:43], v5 offset:5136
ds_read_b64_tr_b16 v[44:45], v5 offset:24
ds_read_b64_tr_b16 v[46:47], v5 offset:5144
ds_read_b64_tr_b16 v[48:49], v5 offset:32
ds_read_b64_tr_b16 v[50:51], v5 offset:5152
ds_read_b64_tr_b16 v[52:53], v5 offset:160
ds_read_b64_tr_b16 v[54:55], v5 offset:5280
ds_read_b64_tr_b16 v[56:57], v5 offset:168
ds_read_b64_tr_b16 v[58:59], v5 offset:5288
ds_read_b64_tr_b16 v[60:61], v5 offset:176
ds_read_b64_tr_b16 v[62:63], v5 offset:5296
ds_read_b64_tr_b16 v[64:65], v5 offset:184
ds_read_b64_tr_b16 v[66:67], v5 offset:5304
ds_read_b64_tr_b16 v[68:69], v5 offset:192
ds_read_b64_tr_b16 v[70:71], v5 offset:5312
s_mul_i32 s44, s70, 696320
s_mul_i32 s45, s71, 5120
s_add_u32 s44, s44, s45
s_add_u32 s44, s44, 9437184
s_cmp_ge_u32 s64, 272
s_cselect_b32 s44, 2147483648, s44
v_lshlrev_b32 v3, 4, v1
v_add_u32 v3, s44, v3
v_add_u32 v4, 4096, v3
v_add_u32 v6, 348160, v3
v_add_u32 v7, 352256, v3
s_waitcnt lgkmcnt(0)
buffer_store_dwordx4 v[32:35], v3, s[40:43], 0 offen offset:0 sc1
buffer_store_dwordx4 v[36:39], v3, s[40:43], 0 offen offset:1024 sc1
buffer_store_dwordx4 v[40:43], v3, s[40:43], 0 offen offset:2048 sc1
buffer_store_dwordx4 v[44:47], v3, s[40:43], 0 offen offset:3072 sc1
buffer_store_dwordx4 v[48:51], v4, s[40:43], 0 offen offset:0 sc1
buffer_store_dwordx4 v[52:55], v6, s[40:43], 0 offen offset:0 sc1
buffer_store_dwordx4 v[56:59], v6, s[40:43], 0 offen offset:1024 sc1
buffer_store_dwordx4 v[60:63], v6, s[40:43], 0 offen offset:2048 sc1
buffer_store_dwordx4 v[64:67], v6, s[40:43], 0 offen offset:3072 sc1
buffer_store_dwordx4 v[68:71], v7, s[40:43], 0 offen offset:0 sc1
s_waitcnt vmcnt(21)
s_barrier
s_add_u32 m0, s60, s48
s_nop 0
buffer_load_dwordx4 v8, s[32:35], s61 offen lds
s_add_u32 m0, s60, s49
s_nop 0
buffer_load_dwordx4 v9, s[32:35], s61 offen lds
s_add_u32 m0, s60, s50
s_nop 0
buffer_load_dwordx4 v10, s[32:35], s61 offen lds
s_add_u32 m0, s60, s51
s_nop 0
buffer_load_dwordx4 v11, s[32:35], s61 offen lds
s_add_u32 m0, s60, s52
s_nop 0
buffer_load_dwordx4 v12, s[36:39], s62 offen lds
s_add_u32 m0, s60, s53
s_nop 0
buffer_load_dwordx4 v13, s[36:39], s62 offen lds
s_add_u32 m0, s60, s54
s_nop 0
buffer_load_dwordx4 v14, s[36:39], s62 offen lds
s_add_u32 m0, s60, s55
s_nop 0
buffer_load_dwordx4 v15, s[36:39], s62 offen lds
s_add_u32 m0, s60, s56
s_nop 0
buffer_load_dwordx4 v16, s[36:39], s62 offen lds
s_add_u32 m0, s60, s57
s_nop 0
buffer_load_dwordx4 v17, s[36:39], s62 offen lds
s_add_u32 s60, s60, 51200
s_cmp_eq_u32 s60, 153600
s_cselect_b32 s60, 0, s60
s_add_u32 s61, s61, 128
s_add_u32 s62, s62, 196608
s_add_u32 s66, s66, 245760
s_add_u32 s59, s59, 1
s_cmp_eq_u32 s59, 10
s_cselect_b32 s59, 0, s59
s_cselect_b32 s61, 0, s61
s_cselect_b32 s62, 0, s62
s_cselect_b32 s66, 0, s66
s_waitcnt vmcnt(20)
s_barrier
s_add_u32 m0, s60, s48
s_nop 0
buffer_load_dwordx4 v8, s[32:35], s61 offen lds
s_add_u32 m0, s60, s49
s_nop 0
buffer_load_dwordx4 v9, s[32:35], s61 offen lds
s_add_u32 m0, s60, s50
s_nop 0
buffer_load_dwordx4 v10, s[32:35], s61 offen lds
s_add_u32 m0, s60, s51
s_nop 0
buffer_load_dwordx4 v11, s[32:35], s61 offen lds
s_add_u32 m0, s60, s52
s_nop 0
buffer_load_dwordx4 v12, s[36:39], s62 offen lds
s_add_u32 m0, s60, s53
s_nop 0
buffer_load_dwordx4 v13, s[36:39], s62 offen lds
s_add_u32 m0, s60, s54
s_nop 0
buffer_load_dwordx4 v14, s[36:39], s62 offen lds
s_add_u32 m0, s60, s55
s_nop 0
buffer_load_dwordx4 v15, s[36:39], s62 offen lds
s_add_u32 m0, s60, s56
s_nop 0
buffer_load_dwordx4 v16, s[36:39], s62 offen lds
s_add_u32 m0, s60, s57
s_nop 0
buffer_load_dwordx4 v17, s[36:39], s62 offen lds
s_add_u32 s60, s60, 51200
s_cmp_eq_u32 s60, 153600
s_cselect_b32 s60, 0, s60
s_add_u32 s61, s61, 128
s_add_u32 s62, s62, 196608
s_add_u32 s66, s66, 245760
s_add_u32 s59, s59, 1
s_cmp_eq_u32 s59, 10
s_cselect_b32 s59, 0, s59
s_cselect_b32 s61, 0, s61
s_cselect_b32 s62, 0, s62
s_cselect_b32 s66, 0, s66
s_waitcnt vmcnt(10)
s_barrier
v_mov_b32 v2, s65
v_mov_b32 v3, s30
s_mov_b64 exec, 1
buffer_store_dword v3, v2, s[40:43], 0 offen sc1
s_mov_b64 exec, -1
s_waitcnt vmcnt(1)
s_barrier
s_barrier
L_hp_post:
s_setprio 3
s_cmp_eq_u32 s25, 0
s_cbranch_scc1 L_nj_7
s_lshr_b32 s58, s27, 1
s_lshl_b32 s58, s58, 12
s_sub_u32 s44, s25, 1
s_mul_i32 s44, s44, 6
s_min_u32 s44, s44, 11
s_lshl_b32 s44, s44, 7
s_add_u32 s58, s58, s44
s_add_u32 s58, s58, 15826944
s_add_u32 s4, s22, s58
s_addc_u32 s5, s23, 0
s_mov_b32 s47, 32768
L_jp_8:
s_mov_b32 s46, 0
s_load_dwordx4 s[8:11], s[4:5], 0 glc
s_load_dwordx4 s[12:15], s[4:5], 128 glc
s_load_dwordx4 s[16:19], s[4:5], 256 glc
s_waitcnt lgkmcnt(0)
s_xor_b32 s8, s8, s30
s_or_b32 s46, s46, s8
s_xor_b32 s9, s9, s30
s_or_b32 s46, s46, s9
s_xor_b32 s10, s10, s30
s_or_b32 s46, s46, s10
s_xor_b32 s11, s11, s30
s_or_b32 s46, s46, s11
s_xor_b32 s12, s12, s30
s_or_b32 s46, s46, s12
s_xor_b32 s13, s13, s30
s_or_b32 s46, s46, s13
s_xor_b32 s14, s14, s30
s_or_b32 s46, s46, s14
s_xor_b32 s15, s15, s30
s_or_b32 s46, s46, s15
s_xor_b32 s16, s16, s30
s_or_b32 s46, s46, s16
s_xor_b32 s17, s17, s30
s_or_b32 s46, s46, s17
s_xor_b32 s18, s18, s30
s_or_b32 s46, s46, s18
s_xor_b32 s19, s19, s30
s_or_b32 s46, s46, s19
s_load_dwordx4 s[8:11], s[4:5], 384 glc
s_load_dwordx4 s[12:15], s[4:5], 512 glc
s_load_dwordx4 s[16:19], s[4:5], 640 glc
s_waitcnt lgkmcnt(0)
s_xor_b32 s8, s8, s30
s_or_b32 s46, s46, s8
s_xor_b32 s9, s9, s30
s_or_b32 s46, s46, s9
s_xor_b32 s10, s10, s30
s_or_b32 s46, s46, s10
s_xor_b32 s11, s11, s30
s_or_b32 s46, s46, s11
s_xor_b32 s12, s12, s30
s_or_b32 s46, s46, s12
s_xor_b32 s13, s13, s30
s_or_b32 s46, s46, s13
s_xor_b32 s14, s14, s30
s_or_b32 s46, s46, s14
s_xor_b32 s15, s15, s30
s_or_b32 s46, s46, s15
s_xor_b32 s16, s16, s30
s_or_b32 s46, s46, s16
s_xor_b32 s17, s17, s30
s_or_b32 s46, s46, s17
s_xor_b32 s18, s18, s30
s_or_b32 s46, s46, s18
s_xor_b32 s19, s19, s30
s_or_b32 s46, s46, s19
s_cmp_eq_u32 s46, 0
s_cbranch_scc1 L_jpd_9
s_sleep 1
s_sub_u32 s47, s47, 1
s_cmp_lg_u32 s47, 0
s_cbranch_scc1 L_jp_8
L_jpd_9:
v_mov_b32 v2, 161536
v_mov_b32 v3, 1
s_mov_b64 exec, 1
ds_add_u32 v2, v3 offset:56
s_mov_b64 exec, -1
L_nj_7:
s_cmp_eq_u32 s25, 0
s_cbranch_scc0 L_n0_10
s_lshl_b32 s58, s26, 10
s_add_u32 s58, s58, 15728640
s_add_u32 s4, s22, s58
s_addc_u32 s5, s23, 0
s_mov_b32 s47, 32768
L_pf_11:
s_mov_b32 s46, 0
s_load_dword s8, s[4:5], 0 glc
s_load_dword s9, s[4:5], 128 glc
s_load_dword s10, s[4:5], 256 glc
s_load_dword s11, s[4:5], 384 glc
s_load_dword s12, s[4:5], 512 glc
s_load_dword s13, s[4:5], 640 glc
s_load_dword s14, s[4:5], 768 glc
s_load_dword s15, s[4:5], 896 glc
s_waitcnt lgkmcnt(0)
s_xor_b32 s8, s8, s30
s_or_b32 s46, s46, s8
s_xor_b32 s9, s9, s30
s_or_b32 s46, s46, s9
s_xor_b32 s10, s10, s30
s_or_b32 s46, s46, s10
s_xor_b32 s11, s11, s30
s_or_b32 s46, s46, s11
s_xor_b32 s12, s12, s30
s_or_b32 s46, s46, s12
s_xor_b32 s13, s13, s30
s_or_b32 s46, s46, s13
s_xor_b32 s14, s14, s30
s_or_b32 s46, s46, s14
s_xor_b32 s15, s15, s30
s_or_b32 s46, s46, s15
s_cmp_eq_u32 s46, 0
s_cbranch_scc1 L_pfd_12
s_sleep 1
s_sub_u32 s47, s47, 1
s_cmp_lg_u32 s47, 0
s_cbranch_scc1 L_pf_11
L_pfd_12:
v_mov_b32 v2, 161536
v_mov_b32 v3, 1
s_mov_b64 exec, 1
ds_add_u32 v2, v3 offset:8
s_mov_b64 exec, -1
L_n0_10:
s_cmp_eq_u32 s28, 0
s_cbranch_scc1 L_hp_kvcu
s_branch L_hp_or
L_hp_kvcu:
s_sub_u32 s59, s25, 1
s_cmp_lt_u32 s59, 2
s_cbranch_scc0 L_n3x_13
s_lshl_b32 s58, s27, 11
s_lshl_b32 s44, s59, 10
s_add_u32 s58, s58, s44
s_add_u32 s58, s58, 15745024
s_add_u32 s4, s22, s58
s_addc_u32 s5, s23, 0
s_mov_b32 s47, 32768
L_pf_14:
s_mov_b32 s46, 0
s_load_dword s8, s[4:5], 0 glc
s_load_dword s9, s[4:5], 128 glc
s_load_dword s10, s[4:5], 256 glc
s_load_dword s11, s[4:5], 384 glc
s_load_dword s12, s[4:5], 512 glc
s_load_dword s13, s[4:5], 640 glc
s_load_dword s14, s[4:5], 768 glc
s_load_dword s15, s[4:5], 896 glc
s_waitcnt lgkmcnt(0)
s_xor_b32 s8, s8, s30
s_or_b32 s46, s46, s8
s_xor_b32 s9, s9, s30
s_or_b32 s46, s46, s9
s_xor_b32 s10, s10, s30
s_or_b32 s46, s46, s10
s_xor_b32 s11, s11, s30
s_or_b32 s46, s46, s11
s_xor_b32 s12, s12, s30
s_or_b32 s46, s46, s12
s_xor_b32 s13, s13, s30
s_or_b32 s46, s46, s13
s_xor_b32 s14, s14, s30
s_or_b32 s46, s46, s14
s_xor_b32 s15, s15, s30
s_or_b32 s46, s46, s15
s_cmp_eq_u32 s46, 0
s_cbranch_scc1 L_pfd_15
s_sleep 1
s_sub_u32 s47, s47, 1
s_cmp_lg_u32 s47, 0
s_cbranch_scc1 L_pf_14
L_pfd_15:
v_mov_b32 v2, 161536
v_mov_b32 v3, 1
s_mov_b64 exec, 1
ds_add_u32 v2, v3 offset:28
s_mov_b64 exec, -1
L_n3x_13:
v_mov_b32 v2, 161536
s_mov_b32 s47, 1048576
L_lw_16:
ds_read_b32 v3, v2 offset:28
s_waitcnt lgkmcnt(0)
v_readfirstlane_b32 s46, v3
s_nop 1
s_cmp_ge_u32 s46, 2
s_cbranch_scc1 L_lwd_17
s_sub_u32 s47, s47, 1
s_cmp_lg_u32 s47, 0
s_cbranch_scc1 L_lw_16
L_lwd_17:
v_lshrrev_b32 v2, 4, v1
v_and_b32 v3, 15, v1
v_mov_b32 v7, 2147483648
v_add_u32 v4, 2, v2
v_and_b32 v4, 3, v4
v_lshrrev_b32 v5, 2, v3
v_cmp_eq_u32 s[56:57], v4, v5
v_lshlrev_b32 v4, 2, v1
v_lshrrev_b32 v5, 1, v2
v_lshlrev_b32 v6, 6, v2
s_cmp_ge_u32 s25, 2
s_cbranch_scc1 L_kt_18
s_mul_i32 s44, s25, 3072
v_add_u32 v8, s44, v4
v_add_u32 v9, s44, v4
v_add_u32 v9, 1024, v9
v_add_u32 v10, s44, v4
v_add_u32 v10, 2048, v10
s_branch L_kt_20
L_kt_18:
s_cmp_eq_u32 s25, 2
s_cbranch_scc0 L_kt_19
v_lshlrev_b32 v11, 10, v5
v_add3_u32 v11, v11, v4, 0
v_add_u32 v11, 6144, v11
v_cndmask_b32 v8, v7, v11, s[56:57]
v_add_u32 v9, 6144, v6
v_add_u32 v10, 6148, v6
s_branch L_kt_20
L_kt_19:
v_add_u32 v8, 7200, v6
v_add_u32 v9, 7204, v6
v_mul_u32_u24 v11, 1056, v5
v_add3_u32 v10, v11, v6, 0
v_add_u32 v10, 6160, v10
L_kt_20:
s_lshl_b32 s48, s27, 13
s_add_u32 s48, s48, 14680064
buffer_load_dword v16, v8, s[40:43], s48 offen offset:0 sc1
buffer_load_dword v17, v8, s[40:43], s48 offen offset:256 sc1
buffer_load_dword v18, v8, s[40:43], s48 offen offset:512 sc1
buffer_load_dword v19, v8, s[40:43], s48 offen offset:768 sc1
buffer_load_dword v20, v9, s[40:43], s48 offen offset:0 sc1
buffer_load_dword v21, v9, s[40:43], s48 offen offset:256 sc1
buffer_load_dword v22, v9, s[40:43], s48 offen offset:512 sc1
buffer_load_dword v23, v9, s[40:43], s48 offen offset:768 sc1
buffer_load_dword v24, v10, s[40:43], s48 offen offset:0 sc1
buffer_load_dword v25, v10, s[40:43], s48 offen offset:256 sc1
buffer_load_dword v26, v10, s[40:43], s48 offen offset:512 sc1
buffer_load_dword v27, v10, s[40:43], s48 offen offset:768 sc1
s_waitcnt vmcnt(0)
s_mul_i32 s44, s25, 1536
s_add_u32 s44, s44, 153600
v_lshlrev_b32 v4, 3, v1
v_add_u32 v5, s44, v4
v_cvt_pk_bf16_f32 v16, v16, v17
v_cvt_pk_bf16_f32 v17, v18, v19
ds_write_b64 v5, v[16:17] offset:0
v_cvt_pk_bf16_f32 v20, v20, v21
v_cvt_pk_bf16_f32 v21, v22, v23
ds_write_b64 v5, v[20:21] offset:512
v_cvt_pk_bf16_f32 v24, v24, v25
v_cvt_pk_bf16_f32 v25, v26, v27
ds_write_b64 v5, v[24:25] offset:1024
s_waitcnt lgkmcnt(0)
v_mov_b32 v2, 161536
v_mov_b32 v3, 1
s_mov_b64 exec, 1
ds_add_u32 v2, v3 offset:4
s_mov_b64 exec, -1
v_mov_b32 v2, 161536
s_mov_b32 s47, 1048576
L_lw_21:
ds_read_b32 v3, v2 offset:4
s_waitcnt lgkmcnt(0)
v_readfirstlane_b32 s46, v3
s_nop 1
s_cmp_ge_u32 s46, 4
s_cbranch_scc1 L_lwd_22
s_sub_u32 s47, s47, 1
s_cmp_lg_u32 s47, 0
s_cbranch_scc1 L_lw_21
L_lwd_22:
v_lshlrev_b32 v5, 3, v1
v_add_u32 v5, 153600, v5
ds_read_b64 v[68:69], v5 offset:0
ds_read_b64 v[70:71], v5 offset:512
ds_read_b64 v[72:73], v5 offset:1024
ds_read_b64 v[74:75], v5 offset:1536
ds_read_b64 v[76:77], v5 offset:2048
ds_read_b64 v[78:79], v5 offset:2560
ds_read_b64 v[80:81], v5 offset:3072
ds_read_b64 v[82:83], v5 offset:3584
ds_read_b64 v[84:85], v5 offset:4096
ds_read_b64 v[86:87], v5 offset:4608
ds_read_b64 v[88:89], v5 offset:5120
ds_read_b64 v[90:91], v5 offset:5632
v_lshrrev_b32 v2, 4, v1
v_and_b32 v3, 15, v1
v_lshrrev_b32 v5, 2, v3
v_cmp_eq_u32 s[56:57], 0, v2
v_cmp_eq_u32 s[64:65], 2, v5
v_cmp_eq_u32 s[58:59], 1, v2
v_cmp_eq_u32 s[66:67], 3, v5
v_cmp_eq_u32 s[60:61], 2, v2
v_cmp_eq_u32 s[68:69], 0, v5
v_cmp_eq_u32 s[62:63], 3, v2
v_cmp_eq_u32 s[70:71], 1, v5
s_waitcnt lgkmcnt(0)
v_mov_b32 v96, v68
v_mov_b32 v97, v69
v_cndmask_b32 v98, 0, v78, s[56:57]
v_cndmask_b32 v99, 0, v79, s[56:57]
v_cndmask_b32 v100, 0, v76, s[64:65]
v_cndmask_b32 v101, 0, v77, s[64:65]
v_cndmask_b32 v102, 0, v80, s[64:65]
v_cndmask_b32 v103, 0, v81, s[64:65]
v_mov_b32 v104, v82
v_mov_b32 v105, v83
v_cndmask_b32 v106, 0, v90, s[56:57]
v_cndmask_b32 v107, 0, v91, s[56:57]
v_mov_b32 v108, v70
v_mov_b32 v109, v71
v_cndmask_b32 v110, 0, v78, s[58:59]
v_cndmask_b32 v111, 0, v79, s[58:59]
v_cndmask_b32 v112, 0, v76, s[66:67]
v_cndmask_b32 v113, 0, v77, s[66:67]
v_cndmask_b32 v114, 0, v80, s[66:67]
v_cndmask_b32 v115, 0, v81, s[66:67]
v_mov_b32 v116, v84
v_mov_b32 v117, v85
v_cndmask_b32 v118, 0, v90, s[58:59]
v_cndmask_b32 v119, 0, v91, s[58:59]
v_mov_b32 v120, v72
v_mov_b32 v121, v73
v_cndmask_b32 v122, 0, v78, s[60:61]
v_cndmask_b32 v123, 0, v79, s[60:61]
v_cndmask_b32 v124, 0, v76, s[68:69]
v_cndmask_b32 v125, 0, v77, s[68:69]
v_cndmask_b32 v126, 0, v80, s[68:69]
v_cndmask_b32 v127, 0, v81, s[68:69]
v_mov_b32 v128, v86
v_mov_b32 v129, v87
v_cndmask_b32 v130, 0, v90, s[60:61]
v_cndmask_b32 v131, 0, v91, s[60:61]
v_mov_b32 v132, v74
v_mov_b32 v133, v75
v_cndmask_b32 v134, 0, v78, s[62:63]
v_cndmask_b32 v135, 0, v79, s[62:63]
v_cndmask_b32 v136, 0, v76, s[70:71]
v_cndmask_b32 v137, 0, v77, s[70:71]
v_cndmask_b32 v138, 0, v80, s[70:71]
v_cndmask_b32 v139, 0, v81, s[70:71]
v_mov_b32 v140, v88
v_mov_b32 v141, v89
v_cndmask_b32 v142, 0, v90, s[62:63]
v_cndmask_b32 v143, 0, v91, s[62:63]
v_mov_b32 v6, 161536
s_mov_b32 s47, 1048576
L_lw_23:
ds_read_b32 v7, v6 offset:20
s_waitcnt lgkmcnt(0)
v_readfirstlane_b32 s46, v7
s_nop 1
s_cmp_ge_u32 s46, 4
s_cbranch_scc1 L_lwd_24
s_sub_u32 s47, s47, 1
s_cmp_lg_u32 s47, 0
s_cbranch_scc1 L_lw_23
L_lwd_24:
s_lshl_b32 s44, s25, 1
s_add_u32 s44, s44, 0
s_and_b32 s45, s44, 3
s_mul_i32 s45, s45, 2560
s_mov_b32 s46, 143360
s_cmp_lt_u32 s44, 4
s_cselect_b32 s46, 40960, s46
s_add_u32 s45, s45, s46
v_lshlrev_b32 v4, 3, v1
v_add_u32 v5, s45, v4
ds_read_b64 v[16:17], v5 offset:0
ds_read_b64 v[18:19], v5 offset:2048
ds_read_b64 v[20:21], v5 offset:512
ds_read_b64 v[22:23], v5 offset:2048
ds_read_b64 v[24:25], v5 offset:1024
ds_read_b64 v[26:27], v5 offset:2048
ds_read_b64 v[28:29], v5 offset:1536
ds_read_b64 v[30:31], v5 offset:2048
s_lshl_b32 s44, s25, 1
s_add_u32 s44, s44, 1
s_and_b32 s45, s44, 3
s_mul_i32 s45, s45, 2560
s_mov_b32 s46, 143360
s_cmp_lt_u32 s44, 4
s_cselect_b32 s46, 40960, s46
s_add_u32 s45, s45, s46
v_lshlrev_b32 v4, 3, v1
v_add_u32 v5, s45, v4
ds_read_b64 v[32:33], v5 offset:0
ds_read_b64 v[34:35], v5 offset:2048
ds_read_b64 v[36:37], v5 offset:512
ds_read_b64 v[38:39], v5 offset:2048
ds_read_b64 v[40:41], v5 offset:1024
ds_read_b64 v[42:43], v5 offset:2048
ds_read_b64 v[44:45], v5 offset:1536
ds_read_b64 v[46:47], v5 offset:2048
v_lshlrev_b32 v4, 4, v1
s_waitcnt lgkmcnt(0)
v_mfma_f32_16x16x32_bf16 v[48:51], v[96:99], v[16:19], 0
v_mfma_f32_16x16x32_bf16 v[64:67], v[104:107], v[16:19], 0
v_mfma_f32_16x16x32_bf16 v[80:83], v[100:103], v[16:19], 0
v_mfma_f32_16x16x32_bf16 v[52:55], v[108:111], v[20:23], 0
v_mfma_f32_16x16x32_bf16 v[68:71], v[116:119], v[20:23], 0
v_mfma_f32_16x16x32_bf16 v[80:83], v[112:115], v[20:23], v[80:83]
v_mfma_f32_16x16x32_bf16 v[56:59], v[120:123], v[24:27], 0
v_mfma_f32_16x16x32_bf16 v[72:75], v[128:131], v[24:27], 0
v_mfma_f32_16x16x32_bf16 v[80:83], v[124:127], v[24:27], v[80:83]
v_mfma_f32_16x16x32_bf16 v[60:63], v[132:135], v[28:31], 0
v_mfma_f32_16x16x32_bf16 v[76:79], v[140:143], v[28:31], 0
v_mfma_f32_16x16x32_bf16 v[80:83], v[136:139], v[28:31], v[80:83]
s_mov_b32 s44, 897988541
v_add_f32 v144, s44, v64
v_add_f32 v145, s44, v68
s_nop 0
v_add_f32 v146, s44, v72
s_nop 1
v_add_f32 v147, s44, v76
v_rcp_f32 v144, v144
v_rcp_f32 v145, v145
v_rcp_f32 v146, v146
v_rcp_f32 v147, v147
v_cndmask_b32 v148, v144, v146, s[56:57]
v_cndmask_b32 v148, v148, v147, s[58:59]
v_cndmask_b32 v148, v148, v145, s[62:63]
v_mul_f32 v48, v48, v144
v_mul_f32 v49, v49, v144
v_mul_f32 v50, v50, v144
v_mul_f32 v51, v51, v144
v_mul_f32 v52, v52, v145
v_mul_f32 v53, v53, v145
v_mul_f32 v54, v54, v145
v_mul_f32 v55, v55, v145
v_mul_f32 v56, v56, v146
v_mul_f32 v57, v57, v146
v_mul_f32 v58, v58, v146
v_mul_f32 v59, v59, v146
v_mul_f32 v60, v60, v147
v_mul_f32 v61, v61, v147
v_mul_f32 v62, v62, v147
v_mul_f32 v63, v63, v147
v_mul_f32 v80, v80, v148
v_mul_f32 v81, v81, v148
v_mul_f32 v82, v82, v148
v_mul_f32 v83, v83, v148
v_cvt_pk_bf16_f32 v84, v48, v49
v_cvt_pk_bf16_f32 v85, v50, v51
v_cvt_pk_bf16_f32 v86, v52, v53
v_cvt_pk_bf16_f32 v87, v54, v55
v_cvt_pk_bf16_f32 v88, v56, v57
v_cvt_pk_bf16_f32 v89, v58, v59
v_cvt_pk_bf16_f32 v90, v60, v61
v_cvt_pk_bf16_f32 v91, v62, v63
v_cvt_pk_bf16_f32 v92, v80, v81
v_cvt_pk_bf16_f32 v93, v82, v83
s_lshl_b32 s50, s26, 3
s_lshl_b32 s44, s25, 1
s_add_u32 s50, s50, s44
s_add_u32 s50, s50, 0
s_mul_i32 s44, s50, 69632
s_add_u32 s44, s44, 0
s_lshl_b32 s45, s27, 11
s_add_u32 s45, s45, s44
s_add_u32 s45, s45, 49152
v_add_u32 v5, s45, v4
s_lshr_b32 s45, s27, 1
s_lshl_b32 s45, s45, 10
s_and_b32 s46, s27, 1
s_lshl_b32 s46, s46, 3
s_add_u32 s45, s45, s46
s_add_u32 s45, s45, s44
s_add_u32 s45, s45, 65536
v_add_u32 v6, s45, v4
buffer_store_dwordx4 v[84:87], v5, s[40:43], 0 offen sc1
buffer_store_dwordx4 v[88:91], v5, s[40:43], 0 offen offset:1024 sc1
buffer_store_dwordx2 v[92:93], v6, s[40:43], 0 offen sc1
v_mfma_f32_16x16x32_bf16 v[48:51], v[96:99], v[32:35], 0
v_mfma_f32_16x16x32_bf16 v[64:67], v[104:107], v[32:35], 0
v_mfma_f32_16x16x32_bf16 v[80:83], v[100:103], v[32:35], 0
v_mfma_f32_16x16x32_bf16 v[52:55], v[108:111], v[36:39], 0
v_mfma_f32_16x16x32_bf16 v[68:71], v[116:119], v[36:39], 0
v_mfma_f32_16x16x32_bf16 v[80:83], v[112:115], v[36:39], v[80:83]
v_mfma_f32_16x16x32_bf16 v[56:59], v[120:123], v[40:43], 0
v_mfma_f32_16x16x32_bf16 v[72:75], v[128:131], v[40:43], 0
v_mfma_f32_16x16x32_bf16 v[80:83], v[124:127], v[40:43], v[80:83]
v_mfma_f32_16x16x32_bf16 v[60:63], v[132:135], v[44:47], 0
v_mfma_f32_16x16x32_bf16 v[76:79], v[140:143], v[44:47], 0
v_mfma_f32_16x16x32_bf16 v[80:83], v[136:139], v[44:47], v[80:83]
s_mov_b32 s44, 897988541
v_add_f32 v144, s44, v64
v_add_f32 v145, s44, v68
s_nop 0
v_add_f32 v146, s44, v72
s_nop 1
v_add_f32 v147, s44, v76
v_rcp_f32 v144, v144
v_rcp_f32 v145, v145
v_rcp_f32 v146, v146
v_rcp_f32 v147, v147
v_cndmask_b32 v148, v144, v146, s[56:57]
v_cndmask_b32 v148, v148, v147, s[58:59]
v_cndmask_b32 v148, v148, v145, s[62:63]
v_mul_f32 v48, v48, v144
v_mul_f32 v49, v49, v144
v_mul_f32 v50, v50, v144
v_mul_f32 v51, v51, v144
v_mul_f32 v52, v52, v145
v_mul_f32 v53, v53, v145
v_mul_f32 v54, v54, v145
v_mul_f32 v55, v55, v145
v_mul_f32 v56, v56, v146
v_mul_f32 v57, v57, v146
v_mul_f32 v58, v58, v146
v_mul_f32 v59, v59, v146
v_mul_f32 v60, v60, v147
v_mul_f32 v61, v61, v147
v_mul_f32 v62, v62, v147
v_mul_f32 v63, v63, v147
v_mul_f32 v80, v80, v148
v_mul_f32 v81, v81, v148
v_mul_f32 v82, v82, v148
v_mul_f32 v83, v83, v148
v_cvt_pk_bf16_f32 v148, v48, v49
v_cvt_pk_bf16_f32 v149, v50, v51
v_cvt_pk_bf16_f32 v150, v52, v53
v_cvt_pk_bf16_f32 v151, v54, v55
v_cvt_pk_bf16_f32 v152, v56, v57
v_cvt_pk_bf16_f32 v153, v58, v59
v_cvt_pk_bf16_f32 v154, v60, v61
v_cvt_pk_bf16_f32 v155, v62, v63
v_cvt_pk_bf16_f32 v156, v80, v81
v_cvt_pk_bf16_f32 v157, v82, v83
s_lshl_b32 s50, s26, 3
s_lshl_b32 s44, s25, 1
s_add_u32 s50, s50, s44
s_add_u32 s50, s50, 1
s_mul_i32 s44, s50, 69632
s_add_u32 s44, s44, 0
s_lshl_b32 s45, s27, 11
s_add_u32 s45, s45, s44
s_add_u32 s45, s45, 49152
v_add_u32 v5, s45, v4
s_lshr_b32 s45, s27, 1
s_lshl_b32 s45, s45, 10
s_and_b32 s46, s27, 1
s_lshl_b32 s46, s46, 3
s_add_u32 s45, s45, s46
s_add_u32 s45, s45, s44
s_add_u32 s45, s45, 65536
v_add_u32 v6, s45, v4
buffer_store_dwordx4 v[148:151], v5, s[40:43], 0 offen sc1
buffer_store_dwordx4 v[152:155], v5, s[40:43], 0 offen offset:1024 sc1
buffer_store_dwordx2 v[156:157], v6, s[40:43], 0 offen sc1
s_waitcnt vmcnt(0)
s_lshl_b32 s44, s26, 10
s_lshl_b32 s45, s27, 7
s_add_u32 s44, s44, s45
s_add_u32 s58, s44, 15761408
v_mov_b32 v2, 161536
v_mov_b32 v3, 1
s_mov_b64 exec, 1
ds_add_rtn_u32 v3, v2, v3 offset:24
s_mov_b64 exec, -1
s_waitcnt lgkmcnt(0)
v_readfirstlane_b32 s46, v3
s_nop 1
s_cmp_eq_u32 s46, 3
s_cselect_b32 s47, s58, 2147483648
v_mov_b32 v2, s47
v_mov_b32 v3, s30
s_mov_b64 exec, 1
buffer_store_dword v3, v2, s[40:43], 0 offen sc1
s_mov_b64 exec, -1
L_hp_or:
s_cmp_eq_u32 s25, 0
s_cbranch_scc0 L_n1_25
s_lshl_b32 s58, s26, 10
s_add_u32 s58, s58, 15761408
s_add_u32 s4, s22, s58
s_addc_u32 s5, s23, 0
s_mov_b32 s47, 32768
L_pf_26:
s_mov_b32 s46, 0
s_load_dword s8, s[4:5], 0 glc
s_load_dword s9, s[4:5], 128 glc
s_load_dword s10, s[4:5], 256 glc
s_load_dword s11, s[4:5], 384 glc
s_load_dword s12, s[4:5], 512 glc
s_load_dword s13, s[4:5], 640 glc
s_load_dword s14, s[4:5], 768 glc
s_load_dword s15, s[4:5], 896 glc
s_waitcnt lgkmcnt(0)
s_xor_b32 s8, s8, s30
s_or_b32 s46, s46, s8
s_xor_b32 s9, s9, s30
s_or_b32 s46, s46, s9
s_xor_b32 s10, s10, s30
s_or_b32 s46, s46, s10
s_xor_b32 s11, s11, s30
s_or_b32 s46, s46, s11
s_xor_b32 s12, s12, s30
s_or_b32 s46, s46, s12
s_xor_b32 s13, s13, s30
s_or_b32 s46, s46, s13
s_xor_b32 s14, s14, s30
s_or_b32 s46, s46, s14
s_xor_b32 s15, s15, s30
s_or_b32 s46, s46, s15
s_cmp_eq_u32 s46, 0
s_cbranch_scc1 L_pfd_27
s_sleep 1
s_sub_u32 s47, s47, 1
s_cmp_lg_u32 s47, 0
s_cbranch_scc1 L_pf_26
L_pfd_27:
v_mov_b32 v2, 161536
v_mov_b32 v3, 1
s_mov_b64 exec, 1
ds_add_u32 v2, v3 offset:12
s_mov_b64 exec, -1
L_n1_25:
s_waitcnt lgkmcnt(0)
s_branch L_end
L_compute:
s_cmp_eq_u32 s25, 0
s_cbranch_scc0 L_c_n0
v_lshlrev_b32 v3, 2, v1
v_add_u32 v3, 161536, v3
v_mov_b32 v4, 0
s_mov_b64 exec, -2
ds_write_b32 v3, v4
s_mov_b64 exec, -1
s_cmp_eq_u32 s2, 0
s_cbranch_scc0 L_c_n0
s_memrealtime s[44:45]
s_mov_b32 s96, s20
s_mov_b32 s97, s21
s_movk_i32 s98, 256
s_mov_b32 s99, 0x20000
s_waitcnt lgkmcnt(0)
s_or_b32 s44, s44, 1
v_mov_b32 v3, s44
v_mov_b32 v4, 0
s_mov_b64 exec, 1
buffer_store_dword v3, v4, s[96:99], 0 offen sc1
s_mov_b64 exec, -1
L_c_n0:
s_cmp_eq_u32 s25, 3
s_cbranch_scc0 L_c_n3
s_mov_b64 exec, 0xff
s_lshl_b32 s44, s31, 10
v_lshlrev_b32 v3, 7, v1
v_add_u32 v3, s44, v3
v_min_u32 v3, .Lcode_end-gated_mix__linear_attn_block__dense_activation_relu__prompt_kernel-512, v3
global_load_dword v31, v3, s[74:75]
s_mov_b64 exec, -1
s_mov_b32 s96, s20
s_mov_b32 s97, s21
s_movk_i32 s98, 256
s_mov_b32 s99, 0x20000
v_mov_b32 v4, 0
s_mov_b32 s47, 131072
L_c_tag:
buffer_load_dword v3, v4, s[96:99], 0 offen sc1
s_waitcnt vmcnt(0)
v_readfirstlane_b32 s44, v3
s_nop 1
s_cmp_lg_u32 s44, 0
s_cbranch_scc1 L_c_tagd
s_sub_u32 s47, s47, 1
s_cmp_lg_u32 s47, 0
s_cbranch_scc1 L_c_tag
L_c_tagd:
v_mov_b32 v2, 161536
ds_write_b32 v2, v3 offset:0
L_c_n3:
s_cmp_eq_u32 s28, 0
s_cbranch_scc0 L_c_h
s_lshr_b32 s48, s25, 1
s_and_b32 s49, s25, 1
v_lshrrev_b32 v2, 4, v1
v_bfe_u32 v3, v1, 2, 2
v_and_b32 v4, 3, v1
v_bfe_u32 v5, v1, 3, 1
s_lshl_b32 s44, s48, 3
v_add_u32 v5, s44, v5
v_lshlrev_b32 v5, 10, v5
v_and_b32 v6, 7, v1
v_lshl_add_u32 v5, v6, 7, v5
v_xor_b32 v7, v2, v6
v_lshl_add_u32 v8, v7, 4, v5
v_xor_b32 v7, 4, v7
v_lshl_add_u32 v9, v7, 4, v5
v_lshrrev_b32 v5, 1, v2
v_lshlrev_b32 v5, 4, v5
v_and_b32 v6, 1, v2
v_lshl_add_u32 v5, v6, 2, v5
v_add_u32 v5, v5, v3
s_and_b32 s45, s27, 3
s_lshl_b32 s45, s45, 1
s_add_u32 s53, s45, s28
s_and_b32 s45, s26, 3
s_mul_i32 s45, s45, 3
s_add_u32 s53, s53, s45
s_cmp_ge_u32 s53, 10
s_cselect_b32 s45, 10, 0
s_sub_u32 s53, s53, s45
s_lshl_b32 s44, s53, 7
s_add_u32 s44, s44, 159744
v_lshlrev_b32 v19, 4, v2
v_add_u32 v19, s44, v19
v_mul_u32_u24 v6, 160, v5
v_add_u32 v7, 40960, v6
s_mul_i32 s44, s49, 80
v_lshlrev_b32 v16, 3, v4
v_add3_u32 v16, v16, v7, s44
v_mul_u32_u24 v17, 40, v4
v_add3_u32 v17, v17, v7, 32
v_add_u32 v6, 16384, v6
v_lshlrev_b32 v7, 3, v4
v_add3_u32 v10, v6, v7, s44
v_lshrrev_b32 v7, 1, v4
v_xor_b32 v7, s49, v7
v_mul_u32_u24 v7, 10256, v7
v_and_b32 v13, 1, v4
v_mul_u32_u24 v13, 40, v13
v_add3_u32 v13, v13, v6, s44
v_add3_u32 v11, v13, v7, 32
v_mov_b32 v32, 0
v_mov_b32 v33, 0
v_mov_b32 v34, 0
v_mov_b32 v35, 0
v_mov_b32 v36, 0
v_mov_b32 v37, 0
v_mov_b32 v38, 0
v_mov_b32 v39, 0
v_mov_b32 v40, 0
v_mov_b32 v41, 0
v_mov_b32 v42, 0
v_mov_b32 v43, 0
v_mov_b32 v44, 0
v_mov_b32 v45, 0
v_mov_b32 v46, 0
v_mov_b32 v47, 0
v_mov_b32 v48, 0
v_mov_b32 v49, 0
v_mov_b32 v50, 0
v_mov_b32 v51, 0
v_mov_b32 v52, 0
v_mov_b32 v53, 0
v_mov_b32 v54, 0
v_mov_b32 v55, 0
v_mov_b32 v56, 0
v_mov_b32 v57, 0
v_mov_b32 v58, 0
v_mov_b32 v59, 0
v_mov_b32 v60, 0
v_mov_b32 v61, 0
v_mov_b32 v62, 0
v_mov_b32 v63, 0
v_mov_b32 v64, 0
v_mov_b32 v65, 0
v_mov_b32 v66, 0
v_mov_b32 v67, 0
v_mov_b32 v68, 0
v_mov_b32 v69, 0
v_mov_b32 v70, 0
v_mov_b32 v71, 0
v_mov_b32 v72, 0
v_mov_b32 v73, 0
v_mov_b32 v74, 0
v_mov_b32 v75, 0
v_mov_b32 v76, 0
v_mov_b32 v77, 0
v_mov_b32 v78, 0
v_mov_b32 v79, 0
v_mov_b32 v80, 0
v_mov_b32 v81, 0
v_mov_b32 v82, 0
v_mov_b32 v83, 0
v_mov_b32 v84, 0
v_mov_b32 v85, 0
v_mov_b32 v86, 0
v_mov_b32 v87, 0
v_mov_b32 v88, 0
v_mov_b32 v89, 0
v_mov_b32 v90, 0
v_mov_b32 v91, 0
v_mov_b32 v92, 0
v_mov_b32 v93, 0
v_mov_b32 v94, 0
v_mov_b32 v95, 0
v_mov_b32 v96, 0
v_mov_b32 v97, 0
v_mov_b32 v98, 0
v_mov_b32 v99, 0
v_mov_b32 v100, 0
v_mov_b32 v101, 0
v_mov_b32 v102, 0
v_mov_b32 v103, 0
v_mov_b32 v104, 0
v_mov_b32 v105, 0
v_mov_b32 v106, 0
v_mov_b32 v107, 0
v_mov_b32 v108, 0
v_mov_b32 v109, 0
v_mov_b32 v110, 0
v_mov_b32 v111, 0
v_mov_b32 v112, 0
v_mov_b32 v113, 0
v_mov_b32 v114, 0
v_mov_b32 v115, 0
v_mov_b32 v116, 0
v_mov_b32 v117, 0
v_mov_b32 v118, 0
v_mov_b32 v119, 0
v_mov_b32 v120, 0
v_mov_b32 v121, 0
v_mov_b32 v122, 0
v_mov_b32 v123, 0
v_mov_b32 v124, 0
v_mov_b32 v125, 0
v_mov_b32 v126, 0
v_mov_b32 v127, 0
v_mov_b32 v128, 0
v_mov_b32 v129, 0
v_mov_b32 v130, 0
v_mov_b32 v131, 0
v_mov_b32 v132, 0
v_mov_b32 v133, 0
v_mov_b32 v134, 0
v_mov_b32 v135, 0
v_mov_b32 v136, 0
v_mov_b32 v137, 0
v_mov_b32 v138, 0
v_mov_b32 v139, 0
v_mov_b32 v140, 0
v_mov_b32 v141, 0
v_mov_b32 v142, 0
v_mov_b32 v143, 0
v_mov_b32 v144, 0
v_mov_b32 v145, 0
v_mov_b32 v146, 0
v_mov_b32 v147, 0
v_mov_b32 v148, 0
v_mov_b32 v149, 0
v_mov_b32 v150, 0
v_mov_b32 v151, 0
v_mov_b32 v152, 0
v_mov_b32 v153, 0
v_mov_b32 v154, 0
v_mov_b32 v155, 0
s_mov_b32 s50, 0
s_mov_b32 s51, 10
s_mov_b32 s55, 51200
s_movk_i32 s54, 128
s_waitcnt lgkmcnt(0)
s_barrier
v_mov_b32 v2, 161536
ds_read_b32 v3, v2 offset:0
ds_read_b128 a[0:3], v8 offset:0
ds_read_b64_tr_b16 a[16:17], v10 offset:0
ds_read_b64_tr_b16 a[18:19], v10 offset:1280
ds_read_b64_tr_b16 a[20:21], v10 offset:40
ds_read_b64_tr_b16 a[22:23], v10 offset:1320
ds_read_b128 a[4:7], v8 offset:2048
ds_read_b64_tr_b16 a[24:25], v10 offset:10256
ds_read_b64_tr_b16 a[26:27], v10 offset:11536
ds_read_b64_tr_b16 a[28:29], v10 offset:10296
ds_read_b64_tr_b16 a[30:31], v10 offset:11576
ds_read_b128 a[8:11], v8 offset:4096
ds_read_b64_tr_b16 a[32:33], v11 offset:0
ds_read_b64_tr_b16 a[34:35], v11 offset:1280
ds_read_b128 a[12:15], v8 offset:6144
ds_read_b64_tr_b16 a[72:73], v16 offset:0
ds_read_b64_tr_b16 a[76:77], v16 offset:40
ds_read_b64_tr_b16 a[80:81], v17 offset:0
ds_read_b64_tr_b16 a[74:75], v16 offset:1280
ds_read_b64_tr_b16 a[78:79], v16 offset:1320
ds_read_b64_tr_b16 a[82:83], v17 offset:1280
ds_read_b128 a[84:87], v19 offset:0
s_waitcnt lgkmcnt(0)
v_readfirstlane_b32 s30, v3
L_t12_loop_kv:
v_mfma_f32_16x16x32_bf16 v[112:115], a[72:75], a[0:3], v[112:115]
v_mfma_f32_16x16x32_bf16 v[128:131], a[76:79], a[0:3], v[128:131]
v_mfma_f32_16x16x32_bf16 v[116:119], a[72:75], a[4:7], v[116:119]
v_mfma_f32_16x16x32_bf16 v[132:135], a[76:79], a[4:7], v[132:135]
v_mfma_f32_16x16x32_bf16 v[120:123], a[72:75], a[8:11], v[120:123]
v_mfma_f32_16x16x32_bf16 v[136:139], a[76:79], a[8:11], v[136:139]
v_mfma_f32_16x16x32_bf16 v[124:127], a[72:75], a[12:15], v[124:127]
v_mfma_f32_16x16x32_bf16 v[140:143], a[76:79], a[12:15], v[140:143]
s_cmp_eq_u32 s49, 0
s_cbranch_scc0 L_qm_28
v_mfma_f32_16x16x32_bf16 v[144:147], a[80:83], a[0:3], v[144:147]
v_mfma_f32_16x16x32_bf16 v[148:151], a[80:83], a[4:7], v[148:151]
v_mfma_f32_16x16x32_bf16 v[152:155], a[84:87], a[0:3], v[152:155]
s_branch L_qm_29
L_qm_28:
v_mfma_f32_16x16x32_bf16 v[144:147], a[80:83], a[8:11], v[144:147]
v_mfma_f32_16x16x32_bf16 v[148:151], a[80:83], a[12:15], v[148:151]
v_mfma_f32_16x16x32_bf16 v[152:155], a[84:87], a[4:7], v[152:155]
L_qm_29:
v_mfma_f32_16x16x32_bf16 v[32:35], a[0:3], a[16:19], v[32:35]
ds_read_b64_tr_b16 a[72:73], v16 offset:5120
ds_read_b64_tr_b16 a[76:77], v16 offset:5160
v_mfma_f32_16x16x32_bf16 v[48:51], a[0:3], a[20:23], v[48:51]
ds_read_b64_tr_b16 a[80:81], v17 offset:5120
ds_read_b64_tr_b16 a[74:75], v16 offset:6400
v_mfma_f32_16x16x32_bf16 v[64:67], a[0:3], a[24:27], v[64:67]
ds_read_b64_tr_b16 a[78:79], v16 offset:6440
ds_read_b64_tr_b16 a[82:83], v17 offset:6400
v_mfma_f32_16x16x32_bf16 v[80:83], a[0:3], a[28:31], v[80:83]
ds_read_b128 a[84:87], v19 offset:64
ds_read_b128 a[36:39], v9 offset:0
v_mfma_f32_16x16x32_bf16 v[96:99], a[0:3], a[32:35], v[96:99]
ds_read_b64_tr_b16 a[52:53], v10 offset:5120
ds_read_b64_tr_b16 a[54:55], v10 offset:6400
v_mfma_f32_16x16x32_bf16 v[36:39], a[4:7], a[16:19], v[36:39]
ds_read_b64_tr_b16 a[56:57], v10 offset:5160
ds_read_b64_tr_b16 a[58:59], v10 offset:6440
v_mfma_f32_16x16x32_bf16 v[52:55], a[4:7], a[20:23], v[52:55]
ds_read_b128 a[40:43], v9 offset:2048
ds_read_b64_tr_b16 a[60:61], v10 offset:15376
v_mfma_f32_16x16x32_bf16 v[68:71], a[4:7], a[24:27], v[68:71]
ds_read_b64_tr_b16 a[62:63], v10 offset:16656
ds_read_b64_tr_b16 a[64:65], v10 offset:15416
v_mfma_f32_16x16x32_bf16 v[84:87], a[4:7], a[28:31], v[84:87]
ds_read_b64_tr_b16 a[66:67], v10 offset:16696
ds_read_b128 a[44:47], v9 offset:4096
v_mfma_f32_16x16x32_bf16 v[100:103], a[4:7], a[32:35], v[100:103]
ds_read_b64_tr_b16 a[68:69], v11 offset:5120
ds_read_b64_tr_b16 a[70:71], v11 offset:6400
v_mfma_f32_16x16x32_bf16 v[40:43], a[8:11], a[16:19], v[40:43]
ds_read_b128 a[48:51], v9 offset:6144
s_add_u32 s50, s50, 1
v_mfma_f32_16x16x32_bf16 v[56:59], a[8:11], a[20:23], v[56:59]
s_cmp_eq_u32 s50, 3
s_cselect_b32 s52, 4294864896, s55
v_mfma_f32_16x16x32_bf16 v[72:75], a[8:11], a[24:27], v[72:75]
s_cselect_b32 s50, 0, s50
v_add_u32 v8, s52, v8
v_mfma_f32_16x16x32_bf16 v[88:91], a[8:11], a[28:31], v[88:91]
v_add_u32 v9, s52, v9
v_add_u32 v10, s52, v10
v_mfma_f32_16x16x32_bf16 v[104:107], a[8:11], a[32:35], v[104:107]
v_add_u32 v11, s52, v11
v_add_u32 v16, s52, v16
v_mfma_f32_16x16x32_bf16 v[44:47], a[12:15], a[16:19], v[44:47]
v_add_u32 v17, s52, v17
s_add_u32 s53, s53, 1
v_mfma_f32_16x16x32_bf16 v[60:63], a[12:15], a[20:23], v[60:63]
s_cmp_eq_u32 s53, 10
s_cselect_b32 s52, 4294966144, s54
v_mfma_f32_16x16x32_bf16 v[76:79], a[12:15], a[24:27], v[76:79]
s_cselect_b32 s53, 0, s53
v_add_u32 v19, s52, v19
v_mfma_f32_16x16x32_bf16 v[92:95], a[12:15], a[28:31], v[92:95]
v_mfma_f32_16x16x32_bf16 v[108:111], a[12:15], a[32:35], v[108:111]
s_waitcnt lgkmcnt(0)
s_barrier
v_mfma_f32_16x16x32_bf16 v[112:115], a[72:75], a[36:39], v[112:115]
v_mfma_f32_16x16x32_bf16 v[128:131], a[76:79], a[36:39], v[128:131]
v_mfma_f32_16x16x32_bf16 v[116:119], a[72:75], a[40:43], v[116:119]
v_mfma_f32_16x16x32_bf16 v[132:135], a[76:79], a[40:43], v[132:135]
v_mfma_f32_16x16x32_bf16 v[120:123], a[72:75], a[44:47], v[120:123]
v_mfma_f32_16x16x32_bf16 v[136:139], a[76:79], a[44:47], v[136:139]
v_mfma_f32_16x16x32_bf16 v[124:127], a[72:75], a[48:51], v[124:127]
v_mfma_f32_16x16x32_bf16 v[140:143], a[76:79], a[48:51], v[140:143]
s_cmp_eq_u32 s49, 0
s_cbranch_scc0 L_qm_30
v_mfma_f32_16x16x32_bf16 v[144:147], a[80:83], a[36:39], v[144:147]
v_mfma_f32_16x16x32_bf16 v[148:151], a[80:83], a[40:43], v[148:151]
v_mfma_f32_16x16x32_bf16 v[152:155], a[84:87], a[36:39], v[152:155]
s_branch L_qm_31
L_qm_30:
v_mfma_f32_16x16x32_bf16 v[144:147], a[80:83], a[44:47], v[144:147]
v_mfma_f32_16x16x32_bf16 v[148:151], a[80:83], a[48:51], v[148:151]
v_mfma_f32_16x16x32_bf16 v[152:155], a[84:87], a[40:43], v[152:155]
L_qm_31:
v_mfma_f32_16x16x32_bf16 v[32:35], a[36:39], a[52:55], v[32:35]
ds_read_b64_tr_b16 a[72:73], v16 offset:0
ds_read_b64_tr_b16 a[76:77], v16 offset:40
v_mfma_f32_16x16x32_bf16 v[48:51], a[36:39], a[56:59], v[48:51]
ds_read_b64_tr_b16 a[80:81], v17 offset:0
ds_read_b64_tr_b16 a[74:75], v16 offset:1280
v_mfma_f32_16x16x32_bf16 v[64:67], a[36:39], a[60:63], v[64:67]
ds_read_b64_tr_b16 a[78:79], v16 offset:1320
ds_read_b64_tr_b16 a[82:83], v17 offset:1280
v_mfma_f32_16x16x32_bf16 v[80:83], a[36:39], a[64:67], v[80:83]
ds_read_b128 a[84:87], v19 offset:0
ds_read_b128 a[0:3], v8 offset:0
v_mfma_f32_16x16x32_bf16 v[96:99], a[36:39], a[68:71], v[96:99]
ds_read_b64_tr_b16 a[16:17], v10 offset:0
ds_read_b64_tr_b16 a[18:19], v10 offset:1280
v_mfma_f32_16x16x32_bf16 v[36:39], a[40:43], a[52:55], v[36:39]
ds_read_b64_tr_b16 a[20:21], v10 offset:40
ds_read_b64_tr_b16 a[22:23], v10 offset:1320
v_mfma_f32_16x16x32_bf16 v[52:55], a[40:43], a[56:59], v[52:55]
ds_read_b128 a[4:7], v8 offset:2048
ds_read_b64_tr_b16 a[24:25], v10 offset:10256
v_mfma_f32_16x16x32_bf16 v[68:71], a[40:43], a[60:63], v[68:71]
ds_read_b64_tr_b16 a[26:27], v10 offset:11536
ds_read_b64_tr_b16 a[28:29], v10 offset:10296
v_mfma_f32_16x16x32_bf16 v[84:87], a[40:43], a[64:67], v[84:87]
ds_read_b64_tr_b16 a[30:31], v10 offset:11576
ds_read_b128 a[8:11], v8 offset:4096
v_mfma_f32_16x16x32_bf16 v[100:103], a[40:43], a[68:71], v[100:103]
ds_read_b64_tr_b16 a[32:33], v11 offset:0
ds_read_b64_tr_b16 a[34:35], v11 offset:1280
v_mfma_f32_16x16x32_bf16 v[40:43], a[44:47], a[52:55], v[40:43]
ds_read_b128 a[12:15], v8 offset:6144
v_mfma_f32_16x16x32_bf16 v[56:59], a[44:47], a[56:59], v[56:59]
v_mfma_f32_16x16x32_bf16 v[72:75], a[44:47], a[60:63], v[72:75]
v_mfma_f32_16x16x32_bf16 v[88:91], a[44:47], a[64:67], v[88:91]
v_mfma_f32_16x16x32_bf16 v[104:107], a[44:47], a[68:71], v[104:107]
v_mfma_f32_16x16x32_bf16 v[44:47], a[48:51], a[52:55], v[44:47]
v_mfma_f32_16x16x32_bf16 v[60:63], a[48:51], a[56:59], v[60:63]
v_mfma_f32_16x16x32_bf16 v[76:79], a[48:51], a[60:63], v[76:79]
v_mfma_f32_16x16x32_bf16 v[92:95], a[48:51], a[64:67], v[92:95]
v_mfma_f32_16x16x32_bf16 v[108:111], a[48:51], a[68:71], v[108:111]
s_waitcnt lgkmcnt(0)
s_sub_u32 s51, s51, 1
s_cmp_lg_u32 s51, 0
s_cbranch_scc1 L_t12_loop_kv
s_waitcnt vmcnt(0)
v_lshlrev_b32 v18, 4, v1
s_mov_b32 s53, 1069066811
s_mov_b32 s54, 897988541
v_lshrrev_b32 v2, 4, v1
v_and_b32 v3, 15, v1
v_lshrrev_b32 v4, 3, v3
v_cmp_eq_u32 s[56:57], s49, v4
v_lshrrev_b32 v7, 1, v2
v_cmp_eq_u32 s[58:59], s49, v7
s_mov_b32 s52, 1069066811
s_mov_b32 s66, 897988541
s_mov_b32 s67, 897988541
v_pk_mul_f32 v[20:21], v[32:33], s[52:53]
v_pk_mul_f32 v[22:23], v[34:35], s[52:53]
v_pk_mul_f32 v[24:25], v[48:49], s[52:53]
v_pk_mul_f32 v[26:27], v[50:51], s[52:53]
v_exp_f32 v20, v20 clamp
v_exp_f32 v21, v21 clamp
v_exp_f32 v22, v22 clamp
v_exp_f32 v23, v23 clamp
v_exp_f32 v24, v24 clamp
v_exp_f32 v25, v25 clamp
v_exp_f32 v26, v26 clamp
v_exp_f32 v27, v27 clamp
v_max_f32 v32, 0, v32
v_max_f32 v33, 0, v33
v_max_f32 v34, 0, v34
v_max_f32 v35, 0, v35
v_max_f32 v48, 0, v48
v_max_f32 v49, 0, v49
v_max_f32 v50, 0, v50
v_max_f32 v51, 0, v51
v_pk_add_f32 v[20:21], v[20:21], s[66:67]
v_pk_add_f32 v[22:23], v[22:23], s[66:67]
v_pk_add_f32 v[24:25], v[24:25], s[66:67]
v_pk_add_f32 v[26:27], v[26:27], s[66:67]
v_pk_add_f32 v[32:33], v[32:33], v[20:21]
v_pk_add_f32 v[34:35], v[34:35], v[22:23]
v_pk_add_f32 v[48:49], v[48:49], v[24:25]
v_pk_add_f32 v[50:51], v[50:51], v[26:27]
v_pk_mul_f32 v[20:21], v[96:97], s[52:53]
v_pk_mul_f32 v[22:23], v[98:99], s[52:53]
v_exp_f32 v20, v20 clamp
v_exp_f32 v21, v21 clamp
v_exp_f32 v22, v22 clamp
v_exp_f32 v23, v23 clamp
v_max_f32 v24, 0, v96
v_max_f32 v25, 0, v97
v_max_f32 v26, 0, v98
v_max_f32 v27, 0, v99
v_pk_add_f32 v[20:21], v[20:21], s[66:67]
v_pk_add_f32 v[22:23], v[22:23], s[66:67]
v_pk_add_f32 v[24:25], v[24:25], v[20:21]
v_pk_add_f32 v[26:27], v[26:27], v[22:23]
v_cndmask_b32 v96, v96, v24, s[56:57]
v_cndmask_b32 v97, v97, v25, s[56:57]
v_cndmask_b32 v98, v98, v26, s[56:57]
v_cndmask_b32 v99, v99, v27, s[56:57]
v_pk_mul_f32 v[20:21], v[36:37], s[52:53]
v_pk_mul_f32 v[22:23], v[38:39], s[52:53]
v_pk_mul_f32 v[24:25], v[52:53], s[52:53]
v_pk_mul_f32 v[26:27], v[54:55], s[52:53]
v_exp_f32 v20, v20 clamp
v_exp_f32 v21, v21 clamp
v_exp_f32 v22, v22 clamp
v_exp_f32 v23, v23 clamp
v_exp_f32 v24, v24 clamp
v_exp_f32 v25, v25 clamp
v_exp_f32 v26, v26 clamp
v_exp_f32 v27, v27 clamp
v_max_f32 v36, 0, v36
v_max_f32 v37, 0, v37
v_max_f32 v38, 0, v38
v_max_f32 v39, 0, v39
v_max_f32 v52, 0, v52
v_max_f32 v53, 0, v53
v_max_f32 v54, 0, v54
v_max_f32 v55, 0, v55
v_pk_add_f32 v[20:21], v[20:21], s[66:67]
v_pk_add_f32 v[22:23], v[22:23], s[66:67]
v_pk_add_f32 v[24:25], v[24:25], s[66:67]
v_pk_add_f32 v[26:27], v[26:27], s[66:67]
v_pk_add_f32 v[36:37], v[36:37], v[20:21]
v_pk_add_f32 v[38:39], v[38:39], v[22:23]
v_pk_add_f32 v[52:53], v[52:53], v[24:25]
v_pk_add_f32 v[54:55], v[54:55], v[26:27]
v_pk_mul_f32 v[20:21], v[100:101], s[52:53]
v_pk_mul_f32 v[22:23], v[102:103], s[52:53]
v_exp_f32 v20, v20 clamp
v_exp_f32 v21, v21 clamp
v_exp_f32 v22, v22 clamp
v_exp_f32 v23, v23 clamp
v_max_f32 v24, 0, v100
v_max_f32 v25, 0, v101
v_max_f32 v26, 0, v102
v_max_f32 v27, 0, v103
v_pk_add_f32 v[20:21], v[20:21], s[66:67]
v_pk_add_f32 v[22:23], v[22:23], s[66:67]
v_pk_add_f32 v[24:25], v[24:25], v[20:21]
v_pk_add_f32 v[26:27], v[26:27], v[22:23]
v_cndmask_b32 v100, v100, v24, s[56:57]
v_cndmask_b32 v101, v101, v25, s[56:57]
v_cndmask_b32 v102, v102, v26, s[56:57]
v_cndmask_b32 v103, v103, v27, s[56:57]
v_pk_mul_f32 v[20:21], v[40:41], s[52:53]
v_pk_mul_f32 v[22:23], v[42:43], s[52:53]
v_pk_mul_f32 v[24:25], v[56:57], s[52:53]
v_pk_mul_f32 v[26:27], v[58:59], s[52:53]
v_exp_f32 v20, v20 clamp
v_exp_f32 v21, v21 clamp
v_exp_f32 v22, v22 clamp
v_exp_f32 v23, v23 clamp
v_exp_f32 v24, v24 clamp
v_exp_f32 v25, v25 clamp
v_exp_f32 v26, v26 clamp
v_exp_f32 v27, v27 clamp
v_max_f32 v40, 0, v40
v_max_f32 v41, 0, v41
v_max_f32 v42, 0, v42
v_max_f32 v43, 0, v43
v_max_f32 v56, 0, v56
v_max_f32 v57, 0, v57
v_max_f32 v58, 0, v58
v_max_f32 v59, 0, v59
v_pk_add_f32 v[20:21], v[20:21], s[66:67]
v_pk_add_f32 v[22:23], v[22:23], s[66:67]
v_pk_add_f32 v[24:25], v[24:25], s[66:67]
v_pk_add_f32 v[26:27], v[26:27], s[66:67]
v_pk_add_f32 v[40:41], v[40:41], v[20:21]
v_pk_add_f32 v[42:43], v[42:43], v[22:23]
v_pk_add_f32 v[56:57], v[56:57], v[24:25]
v_pk_add_f32 v[58:59], v[58:59], v[26:27]
v_pk_mul_f32 v[20:21], v[104:105], s[52:53]
v_pk_mul_f32 v[22:23], v[106:107], s[52:53]
v_exp_f32 v20, v20 clamp
v_exp_f32 v21, v21 clamp
v_exp_f32 v22, v22 clamp
v_exp_f32 v23, v23 clamp
v_max_f32 v24, 0, v104
v_max_f32 v25, 0, v105
v_max_f32 v26, 0, v106
v_max_f32 v27, 0, v107
v_pk_add_f32 v[20:21], v[20:21], s[66:67]
v_pk_add_f32 v[22:23], v[22:23], s[66:67]
v_pk_add_f32 v[24:25], v[24:25], v[20:21]
v_pk_add_f32 v[26:27], v[26:27], v[22:23]
v_cndmask_b32 v104, v104, v24, s[56:57]
v_cndmask_b32 v105, v105, v25, s[56:57]
v_cndmask_b32 v106, v106, v26, s[56:57]
v_cndmask_b32 v107, v107, v27, s[56:57]
v_pk_mul_f32 v[20:21], v[44:45], s[52:53]
v_pk_mul_f32 v[22:23], v[46:47], s[52:53]
v_pk_mul_f32 v[24:25], v[60:61], s[52:53]
v_pk_mul_f32 v[26:27], v[62:63], s[52:53]
v_exp_f32 v20, v20 clamp
v_exp_f32 v21, v21 clamp
v_exp_f32 v22, v22 clamp
v_exp_f32 v23, v23 clamp
v_exp_f32 v24, v24 clamp
v_exp_f32 v25, v25 clamp
v_exp_f32 v26, v26 clamp
v_exp_f32 v27, v27 clamp
v_max_f32 v44, 0, v44
v_max_f32 v45, 0, v45
v_max_f32 v46, 0, v46
v_max_f32 v47, 0, v47
v_max_f32 v60, 0, v60
v_max_f32 v61, 0, v61
v_max_f32 v62, 0, v62
v_max_f32 v63, 0, v63
v_pk_add_f32 v[20:21], v[20:21], s[66:67]
v_pk_add_f32 v[22:23], v[22:23], s[66:67]
v_pk_add_f32 v[24:25], v[24:25], s[66:67]
v_pk_add_f32 v[26:27], v[26:27], s[66:67]
v_pk_add_f32 v[44:45], v[44:45], v[20:21]
v_pk_add_f32 v[46:47], v[46:47], v[22:23]
v_pk_add_f32 v[60:61], v[60:61], v[24:25]
v_pk_add_f32 v[62:63], v[62:63], v[26:27]
v_pk_mul_f32 v[20:21], v[108:109], s[52:53]
v_pk_mul_f32 v[22:23], v[110:111], s[52:53]
v_exp_f32 v20, v20 clamp
v_exp_f32 v21, v21 clamp
v_exp_f32 v22, v22 clamp
v_exp_f32 v23, v23 clamp
v_max_f32 v24, 0, v108
v_max_f32 v25, 0, v109
v_max_f32 v26, 0, v110
v_max_f32 v27, 0, v111
v_pk_add_f32 v[20:21], v[20:21], s[66:67]
v_pk_add_f32 v[22:23], v[22:23], s[66:67]
v_pk_add_f32 v[24:25], v[24:25], v[20:21]
v_pk_add_f32 v[26:27], v[26:27], v[22:23]
v_cndmask_b32 v108, v108, v24, s[56:57]
v_cndmask_b32 v109, v109, v25, s[56:57]
v_cndmask_b32 v110, v110, v26, s[56:57]
v_cndmask_b32 v111, v111, v27, s[56:57]
v_cvt_pk_bf16_f32 v32, v32, v33
v_cvt_pk_bf16_f32 v33, v34, v35
v_cvt_pk_bf16_f32 v34, v36, v37
v_cvt_pk_bf16_f32 v35, v38, v39
v_cvt_pk_bf16_f32 v40, v40, v41
v_cvt_pk_bf16_f32 v41, v42, v43
v_cvt_pk_bf16_f32 v42, v44, v45
v_cvt_pk_bf16_f32 v43, v46, v47
v_cvt_pk_bf16_f32 v48, v48, v49
v_cvt_pk_bf16_f32 v49, v50, v51
v_cvt_pk_bf16_f32 v50, v52, v53
v_cvt_pk_bf16_f32 v51, v54, v55
v_cvt_pk_bf16_f32 v56, v56, v57
v_cvt_pk_bf16_f32 v57, v58, v59
v_cvt_pk_bf16_f32 v58, v60, v61
v_cvt_pk_bf16_f32 v59, v62, v63
v_cvt_pk_bf16_f32 v64, v64, v65
v_cvt_pk_bf16_f32 v65, v66, v67
v_cvt_pk_bf16_f32 v66, v68, v69
v_cvt_pk_bf16_f32 v67, v70, v71
v_cvt_pk_bf16_f32 v72, v72, v73
v_cvt_pk_bf16_f32 v73, v74, v75
v_cvt_pk_bf16_f32 v74, v76, v77
v_cvt_pk_bf16_f32 v75, v78, v79
v_cvt_pk_bf16_f32 v80, v80, v81
v_cvt_pk_bf16_f32 v81, v82, v83
v_cvt_pk_bf16_f32 v82, v84, v85
v_cvt_pk_bf16_f32 v83, v86, v87
v_cvt_pk_bf16_f32 v88, v88, v89
v_cvt_pk_bf16_f32 v89, v90, v91
v_cvt_pk_bf16_f32 v90, v92, v93
v_cvt_pk_bf16_f32 v91, v94, v95
v_cvt_pk_bf16_f32 v96, v96, v97
v_cvt_pk_bf16_f32 v97, v98, v99
v_cvt_pk_bf16_f32 v98, v100, v101
v_cvt_pk_bf16_f32 v99, v102, v103
v_cvt_pk_bf16_f32 v104, v104, v105
v_cvt_pk_bf16_f32 v105, v106, v107
v_cvt_pk_bf16_f32 v106, v108, v109
v_cvt_pk_bf16_f32 v107, v110, v111
v_mov_b32 v20, 0x3f803f80
v_mov_b32 v21, 0x3f803f80
v_mov_b32 v22, 0x3f803f80
v_mov_b32 v23, 0x3f803f80
v_mfma_f32_16x16x32_bf16 v[36:39], v[32:35], v[64:67], 0
v_mfma_f32_16x16x32_bf16 v[44:47], v[48:51], v[80:83], 0
v_mfma_f32_16x16x32_bf16 v[52:55], v[32:35], v[96:99], 0
v_mfma_f32_16x16x32_bf16 v[60:63], v[48:51], v[96:99], 0
v_mfma_f32_16x16x32_bf16 v[68:71], v[96:99], v[64:67], 0
v_mfma_f32_16x16x32_bf16 v[76:79], v[96:99], v[80:83], 0
v_mfma_f32_16x16x32_bf16 v[84:87], v[96:99], v[96:99], 0
v_mfma_f32_16x16x32_bf16 v[92:95], v[32:35], v[20:23], 0
v_mfma_f32_16x16x32_bf16 v[100:103], v[48:51], v[20:23], 0
v_mfma_f32_16x16x32_bf16 v[108:111], v[96:99], v[20:23], 0
v_mfma_f32_16x16x32_bf16 v[36:39], v[40:43], v[72:75], v[36:39]
v_mfma_f32_16x16x32_bf16 v[44:47], v[56:59], v[88:91], v[44:47]
v_mfma_f32_16x16x32_bf16 v[52:55], v[40:43], v[104:107], v[52:55]
v_mfma_f32_16x16x32_bf16 v[60:63], v[56:59], v[104:107], v[60:63]
v_mfma_f32_16x16x32_bf16 v[68:71], v[104:107], v[72:75], v[68:71]
v_mfma_f32_16x16x32_bf16 v[76:79], v[104:107], v[88:91], v[76:79]
v_mfma_f32_16x16x32_bf16 v[84:87], v[104:107], v[104:107], v[84:87]
v_mfma_f32_16x16x32_bf16 v[92:95], v[40:43], v[20:23], v[92:95]
v_mfma_f32_16x16x32_bf16 v[100:103], v[56:59], v[20:23], v[100:103]
v_mfma_f32_16x16x32_bf16 v[108:111], v[104:107], v[20:23], v[108:111]
v_bfe_u32 v4, v3, 2, 1
v_cmp_eq_u32 s[60:61], 1, v4
v_and_b32 v4, 1, v2
v_cmp_eq_u32 s[62:63], 1, v4
v_and_b32 v4, 1, v3
v_cmp_eq_u32 s[64:65], 1, v4
v_cndmask_b32 v52, v52, v60, s[60:61]
v_cndmask_b32 v53, v53, v61, s[60:61]
v_cndmask_b32 v54, v54, v62, s[60:61]
v_cndmask_b32 v55, v55, v63, s[60:61]
v_cndmask_b32 v68, v68, v76, s[62:63]
v_cndmask_b32 v69, v69, v77, s[62:63]
v_cndmask_b32 v70, v70, v78, s[62:63]
v_cndmask_b32 v71, v71, v79, s[62:63]
v_cndmask_b32 v92, v92, v100, s[64:65]
v_cndmask_b32 v93, v93, v101, s[64:65]
v_cndmask_b32 v94, v94, v102, s[64:65]
v_cndmask_b32 v95, v95, v103, s[64:65]
s_lshl_b32 s44, s49, 2
v_lshrrev_b32 v4, 1, v3
v_cmp_eq_u32 s[60:61], s44, v4
s_lshl_b32 s44, s49, 3
s_add_u32 s44, s44, 4
v_cmp_eq_u32 s[62:63], s44, v3
v_cndmask_b32 v84, v84, v92, s[60:61]
v_cndmask_b32 v85, v85, v93, s[60:61]
v_cndmask_b32 v86, v86, v94, s[60:61]
v_cndmask_b32 v87, v87, v95, s[60:61]
v_cndmask_b32 v84, v84, v108, s[62:63]
v_cndmask_b32 v85, v85, v109, s[62:63]
v_cndmask_b32 v86, v86, v110, s[62:63]
v_cndmask_b32 v87, v87, v111, s[62:63]
s_mul_i32 s44, s49, 5120
s_add_u32 s44, s44, 92160
v_add_u32 v4, s44, v18
s_cmp_eq_u32 s48, 0
s_cbranch_scc1 L_kr_32
ds_write_b128 v4, v[36:39] offset:0
ds_write_b128 v4, v[44:47] offset:1024
ds_write_b128 v4, v[52:55] offset:2048
ds_write_b128 v4, v[68:71] offset:3072
ds_write_b128 v4, v[84:87] offset:4096
L_kr_32:
s_waitcnt lgkmcnt(0)
v_mov_b32 v5, 161536
v_mov_b32 v6, 1
s_mov_b64 exec, 1
ds_add_u32 v5, v6 offset:64
s_mov_b64 exec, -1
v_mov_b32 v5, 161536
s_mov_b32 s47, 1048576
L_lw_33:
ds_read_b32 v6, v5 offset:64
s_waitcnt lgkmcnt(0)
v_readfirstlane_b32 s46, v6
s_nop 1
s_cmp_ge_u32 s46, 4
s_cbranch_scc1 L_lwd_34
s_sub_u32 s47, s47, 1
s_cmp_lg_u32 s47, 0
s_cbranch_scc1 L_lw_33
L_lwd_34:
ds_read_b128 v[32:35], v4 offset:0
ds_read_b128 v[48:51], v4 offset:1024
ds_read_b128 v[64:67], v4 offset:2048
ds_read_b128 v[80:83], v4 offset:3072
ds_read_b128 v[96:99], v4 offset:4096
s_waitcnt lgkmcnt(0)
v_pk_add_f32 v[36:37], v[36:37], v[32:33]
v_pk_add_f32 v[38:39], v[38:39], v[34:35]
v_pk_add_f32 v[44:45], v[44:45], v[48:49]
v_pk_add_f32 v[46:47], v[46:47], v[50:51]
v_pk_add_f32 v[52:53], v[52:53], v[64:65]
v_pk_add_f32 v[54:55], v[54:55], v[66:67]
v_pk_add_f32 v[68:69], v[68:69], v[80:81]
v_pk_add_f32 v[70:71], v[70:71], v[82:83]
v_pk_add_f32 v[84:85], v[84:85], v[96:97]
v_pk_add_f32 v[86:87], v[86:87], v[98:99]
v_cndmask_b32 v52, v52, 0, s[56:57]
v_cndmask_b32 v53, v53, 0, s[56:57]
v_cndmask_b32 v54, v54, 0, s[56:57]
v_cndmask_b32 v55, v55, 0, s[56:57]
v_cndmask_b32 v68, 0, v68, s[58:59]
v_cndmask_b32 v69, 0, v69, s[58:59]
v_cndmask_b32 v70, 0, v70, s[58:59]
v_cndmask_b32 v71, 0, v71, s[58:59]
v_mov_b32 v5, 161536
s_mov_b32 s47, 1048576
L_lw_35:
ds_read_b32 v6, v5 offset:52
s_waitcnt lgkmcnt(0)
v_readfirstlane_b32 s46, v6
s_nop 1
s_cmp_ge_u32 s46, 2
s_cbranch_scc1 L_lwd_36
s_sub_u32 s47, s47, 1
s_cmp_lg_u32 s47, 0
s_cbranch_scc1 L_lw_35
L_lwd_36:
s_lshl_b32 s44, s27, 13
s_add_u32 s44, s44, 14680064
s_cmp_eq_u32 s48, 0
s_cselect_b32 s44, s44, 2147483648
v_lshlrev_b32 v4, 2, v1
v_add_u32 v4, s44, v4
s_lshl_b32 s45, s49, 11
v_add_u32 v5, s45, v4
v_add_u32 v6, 4096, v4
s_lshl_b32 s45, s49, 10
v_add_u32 v7, s45, v4
v_add_u32 v7, 6144, v7
buffer_atomic_add_f32 v36, v5, s[40:43], 0 offen offset:0
buffer_atomic_add_f32 v37, v5, s[40:43], 0 offen offset:256
buffer_atomic_add_f32 v38, v5, s[40:43], 0 offen offset:512
buffer_atomic_add_f32 v39, v5, s[40:43], 0 offen offset:768
buffer_atomic_add_f32 v44, v5, s[40:43], 0 offen offset:1024
buffer_atomic_add_f32 v45, v5, s[40:43], 0 offen offset:1280
buffer_atomic_add_f32 v46, v5, s[40:43], 0 offen offset:1536
buffer_atomic_add_f32 v47, v5, s[40:43], 0 offen offset:1792
buffer_atomic_add_f32 v52, v6, s[40:43], 0 offen offset:0
buffer_atomic_add_f32 v53, v6, s[40:43], 0 offen offset:256
buffer_atomic_add_f32 v54, v6, s[40:43], 0 offen offset:512
buffer_atomic_add_f32 v55, v6, s[40:43], 0 offen offset:768
buffer_atomic_add_f32 v68, v6, s[40:43], 0 offen offset:1024
buffer_atomic_add_f32 v69, v6, s[40:43], 0 offen offset:1280
buffer_atomic_add_f32 v70, v6, s[40:43], 0 offen offset:1536
buffer_atomic_add_f32 v71, v6, s[40:43], 0 offen offset:1792
buffer_atomic_add_f32 v84, v7, s[40:43], 0 offen offset:0
buffer_atomic_add_f32 v85, v7, s[40:43], 0 offen offset:256
buffer_atomic_add_f32 v86, v7, s[40:43], 0 offen offset:512
buffer_atomic_add_f32 v87, v7, s[40:43], 0 offen offset:768
s_mov_b32 s58, 1069066811
v_mul_f32 v6, s58, v152
v_sub_f32 v6, 0, v6
s_mov_b32 s59, 0x42700000
v_min_f32 v6, s59, v6
v_exp_f32 v6, v6
s_nop 0
v_add_f32 v7, 1.0, v6
v_rcp_f32 v7, v7
s_lshl_b32 s44, s25, 6
v_and_b32 v5, 15, v1
v_lshlrev_b32 v5, 2, v5
v_add_u32 v5, s44, v5
v_add_u32 v5, 161024, v5
ds_write_b32 v5, v7
ds_write_b32 v5, v6 offset:256
s_waitcnt lgkmcnt(0)
v_mov_b32 v2, 161536
v_mov_b32 v3, 1
s_mov_b64 exec, 1
ds_add_u32 v2, v3 offset:44
s_mov_b64 exec, -1
s_mov_b32 s58, 1069066811
s_mov_b32 s59, 1069066811
s_mov_b32 s66, 897988541
s_mov_b32 s67, 897988541
v_pk_mul_f32 v[32:33], v[112:113], s[58:59]
v_pk_mul_f32 v[34:35], v[114:115], s[58:59]
v_pk_mul_f32 v[40:41], v[116:117], s[58:59]
v_pk_mul_f32 v[42:43], v[118:119], s[58:59]
v_pk_mul_f32 v[48:49], v[120:121], s[58:59]
v_pk_mul_f32 v[50:51], v[122:123], s[58:59]
v_pk_mul_f32 v[56:57], v[124:125], s[58:59]
v_pk_mul_f32 v[58:59], v[126:127], s[58:59]
v_pk_mul_f32 v[64:65], v[128:129], s[58:59]
v_pk_mul_f32 v[66:67], v[130:131], s[58:59]
v_pk_mul_f32 v[72:73], v[132:133], s[58:59]
v_pk_mul_f32 v[74:75], v[134:135], s[58:59]
v_pk_mul_f32 v[80:81], v[136:137], s[58:59]
v_pk_mul_f32 v[82:83], v[138:139], s[58:59]
v_pk_mul_f32 v[88:89], v[140:141], s[58:59]
v_pk_mul_f32 v[90:91], v[142:143], s[58:59]
v_pk_mul_f32 v[96:97], v[144:145], s[58:59]
v_pk_mul_f32 v[98:99], v[146:147], s[58:59]
v_pk_mul_f32 v[104:105], v[148:149], s[58:59]
v_pk_mul_f32 v[106:107], v[150:151], s[58:59]
v_exp_f32 v32, v32 clamp
v_exp_f32 v33, v33 clamp
v_exp_f32 v34, v34 clamp
v_exp_f32 v35, v35 clamp
v_exp_f32 v40, v40 clamp
v_exp_f32 v41, v41 clamp
v_exp_f32 v42, v42 clamp
v_exp_f32 v43, v43 clamp
v_exp_f32 v48, v48 clamp
v_exp_f32 v49, v49 clamp
v_exp_f32 v50, v50 clamp
v_exp_f32 v51, v51 clamp
v_exp_f32 v56, v56 clamp
v_exp_f32 v57, v57 clamp
v_exp_f32 v58, v58 clamp
v_exp_f32 v59, v59 clamp
v_exp_f32 v64, v64 clamp
v_exp_f32 v65, v65 clamp
v_exp_f32 v66, v66 clamp
v_exp_f32 v67, v67 clamp
v_exp_f32 v72, v72 clamp
v_exp_f32 v73, v73 clamp
v_exp_f32 v74, v74 clamp
v_exp_f32 v75, v75 clamp
v_exp_f32 v80, v80 clamp
v_exp_f32 v81, v81 clamp
v_exp_f32 v82, v82 clamp
v_exp_f32 v83, v83 clamp
v_exp_f32 v88, v88 clamp
v_exp_f32 v89, v89 clamp
v_exp_f32 v90, v90 clamp
v_exp_f32 v91, v91 clamp
v_exp_f32 v96, v96 clamp
v_exp_f32 v97, v97 clamp
v_exp_f32 v98, v98 clamp
v_exp_f32 v99, v99 clamp
v_exp_f32 v104, v104 clamp
v_exp_f32 v105, v105 clamp
v_exp_f32 v106, v106 clamp
v_exp_f32 v107, v107 clamp
v_max_f32 v112, 0, v112
v_max_f32 v113, 0, v113
v_max_f32 v114, 0, v114
v_max_f32 v115, 0, v115
v_max_f32 v116, 0, v116
v_max_f32 v117, 0, v117
v_max_f32 v118, 0, v118
v_max_f32 v119, 0, v119
v_max_f32 v120, 0, v120
v_max_f32 v121, 0, v121
v_max_f32 v122, 0, v122
v_max_f32 v123, 0, v123
v_max_f32 v124, 0, v124
v_max_f32 v125, 0, v125
v_max_f32 v126, 0, v126
v_max_f32 v127, 0, v127
v_max_f32 v128, 0, v128
v_max_f32 v129, 0, v129
v_max_f32 v130, 0, v130
v_max_f32 v131, 0, v131
v_max_f32 v132, 0, v132
v_max_f32 v133, 0, v133
v_max_f32 v134, 0, v134
v_max_f32 v135, 0, v135
v_max_f32 v136, 0, v136
v_max_f32 v137, 0, v137
v_max_f32 v138, 0, v138
v_max_f32 v139, 0, v139
v_max_f32 v140, 0, v140
v_max_f32 v141, 0, v141
v_max_f32 v142, 0, v142
v_max_f32 v143, 0, v143
v_max_f32 v144, 0, v144
v_max_f32 v145, 0, v145
v_max_f32 v146, 0, v146
v_max_f32 v147, 0, v147
v_max_f32 v148, 0, v148
v_max_f32 v149, 0, v149
v_max_f32 v150, 0, v150
v_max_f32 v151, 0, v151
v_pk_add_f32 v[32:33], v[32:33], s[66:67]
v_pk_add_f32 v[34:35], v[34:35], s[66:67]
v_pk_add_f32 v[40:41], v[40:41], s[66:67]
v_pk_add_f32 v[42:43], v[42:43], s[66:67]
v_pk_add_f32 v[48:49], v[48:49], s[66:67]
v_pk_add_f32 v[50:51], v[50:51], s[66:67]
v_pk_add_f32 v[56:57], v[56:57], s[66:67]
v_pk_add_f32 v[58:59], v[58:59], s[66:67]
v_pk_add_f32 v[64:65], v[64:65], s[66:67]
v_pk_add_f32 v[66:67], v[66:67], s[66:67]
v_pk_add_f32 v[72:73], v[72:73], s[66:67]
v_pk_add_f32 v[74:75], v[74:75], s[66:67]
v_pk_add_f32 v[80:81], v[80:81], s[66:67]
v_pk_add_f32 v[82:83], v[82:83], s[66:67]
v_pk_add_f32 v[88:89], v[88:89], s[66:67]
v_pk_add_f32 v[90:91], v[90:91], s[66:67]
v_pk_add_f32 v[96:97], v[96:97], s[66:67]
v_pk_add_f32 v[98:99], v[98:99], s[66:67]
v_pk_add_f32 v[104:105], v[104:105], s[66:67]
v_pk_add_f32 v[106:107], v[106:107], s[66:67]
v_pk_add_f32 v[112:113], v[112:113], v[32:33]
v_pk_add_f32 v[114:115], v[114:115], v[34:35]
v_pk_add_f32 v[116:117], v[116:117], v[40:41]
v_pk_add_f32 v[118:119], v[118:119], v[42:43]
v_pk_add_f32 v[120:121], v[120:121], v[48:49]
v_pk_add_f32 v[122:123], v[122:123], v[50:51]
v_pk_add_f32 v[124:125], v[124:125], v[56:57]
v_pk_add_f32 v[126:127], v[126:127], v[58:59]
v_pk_add_f32 v[128:129], v[128:129], v[64:65]
v_pk_add_f32 v[130:131], v[130:131], v[66:67]
v_pk_add_f32 v[132:133], v[132:133], v[72:73]
v_pk_add_f32 v[134:135], v[134:135], v[74:75]
v_pk_add_f32 v[136:137], v[136:137], v[80:81]
v_pk_add_f32 v[138:139], v[138:139], v[82:83]
v_pk_add_f32 v[140:141], v[140:141], v[88:89]
v_pk_add_f32 v[142:143], v[142:143], v[90:91]
v_pk_add_f32 v[144:145], v[144:145], v[96:97]
v_pk_add_f32 v[146:147], v[146:147], v[98:99]
v_pk_add_f32 v[148:149], v[148:149], v[104:105]
v_pk_add_f32 v[150:151], v[150:151], v[106:107]
s_mov_b32 s44, 143360
s_cmp_eq_u32 s48, 0
s_cselect_b32 s44, 40960, s44
s_lshl_b32 s45, s49, 10
s_add_u32 s45, s45, s44
v_lshlrev_b32 v5, 3, v1
v_add_u32 v6, s45, v5
v_cvt_pk_bf16_f32 v112, v112, v113
v_cvt_pk_bf16_f32 v113, v114, v115
ds_write_b64 v6, v[112:113] offset:0
v_cvt_pk_bf16_f32 v116, v116, v117
v_cvt_pk_bf16_f32 v117, v118, v119
ds_write_b64 v6, v[116:117] offset:2560
v_cvt_pk_bf16_f32 v120, v120, v121
v_cvt_pk_bf16_f32 v121, v122, v123
ds_write_b64 v6, v[120:121] offset:5120
v_cvt_pk_bf16_f32 v124, v124, v125
v_cvt_pk_bf16_f32 v125, v126, v127
ds_write_b64 v6, v[124:125] offset:7680
v_cvt_pk_bf16_f32 v128, v128, v129
v_cvt_pk_bf16_f32 v129, v130, v131
ds_write_b64 v6, v[128:129] offset:512
v_cvt_pk_bf16_f32 v132, v132, v133
v_cvt_pk_bf16_f32 v133, v134, v135
ds_write_b64 v6, v[132:133] offset:3072
v_cvt_pk_bf16_f32 v136, v136, v137
v_cvt_pk_bf16_f32 v137, v138, v139
ds_write_b64 v6, v[136:137] offset:5632
v_cvt_pk_bf16_f32 v140, v140, v141
v_cvt_pk_bf16_f32 v141, v142, v143
ds_write_b64 v6, v[140:141] offset:8192
s_mul_i32 s45, s49, 5120
s_add_u32 s45, s45, s44
v_add_u32 v6, s45, v5
v_cvt_pk_bf16_f32 v144, v144, v145
v_cvt_pk_bf16_f32 v145, v146, v147
ds_write_b64 v6, v[144:145] offset:2048
v_cvt_pk_bf16_f32 v148, v148, v149
v_cvt_pk_bf16_f32 v149, v150, v151
ds_write_b64 v6, v[148:149] offset:4608
s_waitcnt lgkmcnt(0)
v_mov_b32 v2, 161536
v_mov_b32 v3, 1
s_mov_b64 exec, 1
ds_add_u32 v2, v3 offset:20
s_mov_b64 exec, -1
s_waitcnt vmcnt(0)
s_lshl_b32 s44, s27, 11
s_lshl_b32 s45, s26, 7
s_add_u32 s44, s44, s45
s_add_u32 s44, s44, 15745024
v_mov_b32 v2, 161536
v_mov_b32 v3, 1
s_mov_b64 exec, 1
ds_add_rtn_u32 v3, v2, v3 offset:16
s_mov_b64 exec, -1
s_waitcnt lgkmcnt(0)
v_readfirstlane_b32 s46, v3
s_nop 1
s_cmp_eq_u32 s46, 3
s_cselect_b32 s47, s44, 2147483648
v_mov_b32 v2, s47
v_mov_b32 v3, s30
s_mov_b64 exec, 1
buffer_store_dword v3, v2, s[40:43], 0 offen sc1
s_mov_b64 exec, -1
s_branch L_c_t4
L_c_h:
s_lshr_b32 s48, s25, 1
s_and_b32 s49, s25, 1
v_lshrrev_b32 v2, 4, v1
v_bfe_u32 v3, v1, 2, 2
v_and_b32 v4, 3, v1
v_bfe_u32 v5, v1, 3, 1
s_lshl_b32 s44, s48, 3
v_add_u32 v5, s44, v5
v_lshlrev_b32 v5, 10, v5
v_and_b32 v6, 7, v1
v_lshl_add_u32 v5, v6, 7, v5
v_xor_b32 v7, v2, v6
v_lshl_add_u32 v8, v7, 4, v5
v_xor_b32 v7, 4, v7
v_lshl_add_u32 v9, v7, 4, v5
v_lshrrev_b32 v5, 1, v2
v_lshlrev_b32 v5, 4, v5
v_and_b32 v6, 1, v2
v_lshl_add_u32 v5, v6, 2, v5
v_add_u32 v5, v5, v3
s_and_b32 s45, s27, 3
s_lshl_b32 s45, s45, 1
s_add_u32 s53, s45, s28
s_and_b32 s45, s26, 3
s_mul_i32 s45, s45, 3
s_add_u32 s53, s53, s45
s_cmp_ge_u32 s53, 10
s_cselect_b32 s45, 10, 0
s_sub_u32 s53, s53, s45
s_lshl_b32 s44, s53, 7
s_add_u32 s44, s44, 159744
v_lshlrev_b32 v19, 4, v2
v_add_u32 v19, s44, v19
v_mul_u32_u24 v6, 384, v5
v_add_u32 v6, 16384, v6
v_and_b32 v7, 1, v4
v_lshl_add_u32 v6, v7, 3, v6
v_and_b32 v7, 6, v5
v_lshrrev_b32 v20, 1, v4
s_mul_i32 s44, s49, 12
v_add_u32 v20, s44, v20
v_add_u32 v21, 0, v20
v_xor_b32 v21, v21, v7
v_lshl_add_u32 v10, v21, 4, v6
v_add_u32 v21, 2, v20
v_xor_b32 v21, v21, v7
v_lshl_add_u32 v11, v21, 4, v6
v_add_u32 v21, 4, v20
v_xor_b32 v21, v21, v7
v_lshl_add_u32 v12, v21, 4, v6
v_add_u32 v21, 6, v20
v_xor_b32 v21, v21, v7
v_lshl_add_u32 v13, v21, 4, v6
v_add_u32 v21, 8, v20
v_xor_b32 v21, v21, v7
v_lshl_add_u32 v14, v21, 4, v6
v_add_u32 v21, 10, v20
v_xor_b32 v21, v21, v7
v_lshl_add_u32 v15, v21, 4, v6
v_mov_b32 v32, 0
v_mov_b32 v33, 0
v_mov_b32 v34, 0
v_mov_b32 v35, 0
v_mov_b32 v36, 0
v_mov_b32 v37, 0
v_mov_b32 v38, 0
v_mov_b32 v39, 0
v_mov_b32 v40, 0
v_mov_b32 v41, 0
v_mov_b32 v42, 0
v_mov_b32 v43, 0
v_mov_b32 v44, 0
v_mov_b32 v45, 0
v_mov_b32 v46, 0
v_mov_b32 v47, 0
v_mov_b32 v48, 0
v_mov_b32 v49, 0
v_mov_b32 v50, 0
v_mov_b32 v51, 0
v_mov_b32 v52, 0
v_mov_b32 v53, 0
v_mov_b32 v54, 0
v_mov_b32 v55, 0
v_mov_b32 v56, 0
v_mov_b32 v57, 0
v_mov_b32 v58, 0
v_mov_b32 v59, 0
v_mov_b32 v60, 0
v_mov_b32 v61, 0
v_mov_b32 v62, 0
v_mov_b32 v63, 0
v_mov_b32 v64, 0
v_mov_b32 v65, 0
v_mov_b32 v66, 0
v_mov_b32 v67, 0
v_mov_b32 v68, 0
v_mov_b32 v69, 0
v_mov_b32 v70, 0
v_mov_b32 v71, 0
v_mov_b32 v72, 0
v_mov_b32 v73, 0
v_mov_b32 v74, 0
v_mov_b32 v75, 0
v_mov_b32 v76, 0
v_mov_b32 v77, 0
v_mov_b32 v78, 0
v_mov_b32 v79, 0
v_mov_b32 v80, 0
v_mov_b32 v81, 0
v_mov_b32 v82, 0
v_mov_b32 v83, 0
v_mov_b32 v84, 0
v_mov_b32 v85, 0
v_mov_b32 v86, 0
v_mov_b32 v87, 0
v_mov_b32 v88, 0
v_mov_b32 v89, 0
v_mov_b32 v90, 0
v_mov_b32 v91, 0
v_mov_b32 v92, 0
v_mov_b32 v93, 0
v_mov_b32 v94, 0
v_mov_b32 v95, 0
v_mov_b32 v96, 0
v_mov_b32 v97, 0
v_mov_b32 v98, 0
v_mov_b32 v99, 0
v_mov_b32 v100, 0
v_mov_b32 v101, 0
v_mov_b32 v102, 0
v_mov_b32 v103, 0
v_mov_b32 v104, 0
v_mov_b32 v105, 0
v_mov_b32 v106, 0
v_mov_b32 v107, 0
v_mov_b32 v108, 0
v_mov_b32 v109, 0
v_mov_b32 v110, 0
v_mov_b32 v111, 0
v_mov_b32 v112, 0
v_mov_b32 v113, 0
v_mov_b32 v114, 0
v_mov_b32 v115, 0
v_mov_b32 v116, 0
v_mov_b32 v117, 0
v_mov_b32 v118, 0
v_mov_b32 v119, 0
v_mov_b32 v120, 0
v_mov_b32 v121, 0
v_mov_b32 v122, 0
v_mov_b32 v123, 0
v_mov_b32 v124, 0
v_mov_b32 v125, 0
v_mov_b32 v126, 0
v_mov_b32 v127, 0
v_mov_b32 v128, 0
v_mov_b32 v129, 0
v_mov_b32 v130, 0
v_mov_b32 v131, 0
s_mov_b32 s50, 0
s_mov_b32 s51, 10
s_mov_b32 s55, 51200
s_movk_i32 s54, 128
s_waitcnt lgkmcnt(0)
s_barrier
v_mov_b32 v2, 161536
ds_read_b32 v3, v2 offset:0
ds_read_b128 a[0:3], v8 offset:0
ds_read_b64_tr_b16 a[16:17], v10 offset:0
ds_read_b64_tr_b16 a[18:19], v10 offset:3072
ds_read_b64_tr_b16 a[20:21], v11 offset:0
ds_read_b64_tr_b16 a[22:23], v11 offset:3072
ds_read_b128 a[4:7], v8 offset:2048
ds_read_b64_tr_b16 a[24:25], v12 offset:0
ds_read_b64_tr_b16 a[26:27], v12 offset:3072
ds_read_b64_tr_b16 a[28:29], v13 offset:0
ds_read_b64_tr_b16 a[30:31], v13 offset:3072
ds_read_b128 a[8:11], v8 offset:4096
ds_read_b64_tr_b16 a[32:33], v14 offset:0
ds_read_b64_tr_b16 a[34:35], v14 offset:3072
ds_read_b128 a[12:15], v8 offset:6144
ds_read_b64_tr_b16 a[36:37], v15 offset:0
ds_read_b64_tr_b16 a[38:39], v15 offset:3072
ds_read_b128 a[80:83], v19 offset:0
s_waitcnt lgkmcnt(0)
v_readfirstlane_b32 s30, v3
L_t12_loop_h:
s_cmp_eq_u32 s49, 0
s_cbranch_scc0 L_qm_37
v_mfma_f32_16x16x32_bf16 v[128:131], a[80:83], a[8:11], v[128:131]
s_branch L_qm_38
L_qm_37:
v_mfma_f32_16x16x32_bf16 v[128:131], a[80:83], a[12:15], v[128:131]
L_qm_38:
v_mfma_f32_16x16x32_bf16 v[32:35], a[16:19], a[0:3], v[32:35]
ds_read_b128 a[80:83], v19 offset:64
ds_read_b128 a[40:43], v9 offset:0
v_mfma_f32_16x16x32_bf16 v[48:51], a[20:23], a[0:3], v[48:51]
ds_read_b64_tr_b16 a[56:57], v10 offset:12288
ds_read_b64_tr_b16 a[58:59], v10 offset:15360
v_mfma_f32_16x16x32_bf16 v[64:67], a[24:27], a[0:3], v[64:67]
ds_read_b64_tr_b16 a[60:61], v11 offset:12288
ds_read_b64_tr_b16 a[62:63], v11 offset:15360
v_mfma_f32_16x16x32_bf16 v[80:83], a[28:31], a[0:3], v[80:83]
ds_read_b128 a[44:47], v9 offset:2048
ds_read_b64_tr_b16 a[64:65], v12 offset:12288
v_mfma_f32_16x16x32_bf16 v[96:99], a[32:35], a[0:3], v[96:99]
ds_read_b64_tr_b16 a[66:67], v12 offset:15360
ds_read_b64_tr_b16 a[68:69], v13 offset:12288
v_mfma_f32_16x16x32_bf16 v[112:115], a[36:39], a[0:3], v[112:115]
ds_read_b64_tr_b16 a[70:71], v13 offset:15360
ds_read_b128 a[48:51], v9 offset:4096
v_mfma_f32_16x16x32_bf16 v[36:39], a[16:19], a[4:7], v[36:39]
ds_read_b64_tr_b16 a[72:73], v14 offset:12288
ds_read_b64_tr_b16 a[74:75], v14 offset:15360
v_mfma_f32_16x16x32_bf16 v[52:55], a[20:23], a[4:7], v[52:55]
ds_read_b128 a[52:55], v9 offset:6144
ds_read_b64_tr_b16 a[76:77], v15 offset:12288
v_mfma_f32_16x16x32_bf16 v[68:71], a[24:27], a[4:7], v[68:71]
ds_read_b64_tr_b16 a[78:79], v15 offset:15360
s_add_u32 s50, s50, 1
v_mfma_f32_16x16x32_bf16 v[84:87], a[28:31], a[4:7], v[84:87]
s_cmp_eq_u32 s50, 3
s_cselect_b32 s52, 4294864896, s55
v_mfma_f32_16x16x32_bf16 v[100:103], a[32:35], a[4:7], v[100:103]
s_cselect_b32 s50, 0, s50
v_add_u32 v8, s52, v8
v_mfma_f32_16x16x32_bf16 v[116:119], a[36:39], a[4:7], v[116:119]
v_add_u32 v9, s52, v9
v_add_u32 v10, s52, v10
v_mfma_f32_16x16x32_bf16 v[40:43], a[16:19], a[8:11], v[40:43]
v_add_u32 v11, s52, v11
v_add_u32 v12, s52, v12
v_mfma_f32_16x16x32_bf16 v[56:59], a[20:23], a[8:11], v[56:59]
v_add_u32 v13, s52, v13
v_add_u32 v14, s52, v14
v_mfma_f32_16x16x32_bf16 v[72:75], a[24:27], a[8:11], v[72:75]
v_add_u32 v15, s52, v15
s_add_u32 s53, s53, 1
v_mfma_f32_16x16x32_bf16 v[88:91], a[28:31], a[8:11], v[88:91]
s_cmp_eq_u32 s53, 10
s_cselect_b32 s52, 4294966144, s54
v_mfma_f32_16x16x32_bf16 v[104:107], a[32:35], a[8:11], v[104:107]
s_cselect_b32 s53, 0, s53
v_add_u32 v19, s52, v19
v_mfma_f32_16x16x32_bf16 v[120:123], a[36:39], a[8:11], v[120:123]
v_mfma_f32_16x16x32_bf16 v[44:47], a[16:19], a[12:15], v[44:47]
v_mfma_f32_16x16x32_bf16 v[60:63], a[20:23], a[12:15], v[60:63]
v_mfma_f32_16x16x32_bf16 v[76:79], a[24:27], a[12:15], v[76:79]
v_mfma_f32_16x16x32_bf16 v[92:95], a[28:31], a[12:15], v[92:95]
v_mfma_f32_16x16x32_bf16 v[108:111], a[32:35], a[12:15], v[108:111]
v_mfma_f32_16x16x32_bf16 v[124:127], a[36:39], a[12:15], v[124:127]
s_waitcnt lgkmcnt(0)
s_barrier
s_cmp_eq_u32 s49, 0
s_cbranch_scc0 L_qm_39
v_mfma_f32_16x16x32_bf16 v[128:131], a[80:83], a[48:51], v[128:131]
s_branch L_qm_40
L_qm_39:
v_mfma_f32_16x16x32_bf16 v[128:131], a[80:83], a[52:55], v[128:131]
L_qm_40:
v_mfma_f32_16x16x32_bf16 v[32:35], a[56:59], a[40:43], v[32:35]
ds_read_b128 a[80:83], v19 offset:0
ds_read_b128 a[0:3], v8 offset:0
v_mfma_f32_16x16x32_bf16 v[48:51], a[60:63], a[40:43], v[48:51]
ds_read_b64_tr_b16 a[16:17], v10 offset:0
ds_read_b64_tr_b16 a[18:19], v10 offset:3072
v_mfma_f32_16x16x32_bf16 v[64:67], a[64:67], a[40:43], v[64:67]
ds_read_b64_tr_b16 a[20:21], v11 offset:0
ds_read_b64_tr_b16 a[22:23], v11 offset:3072
v_mfma_f32_16x16x32_bf16 v[80:83], a[68:71], a[40:43], v[80:83]
ds_read_b128 a[4:7], v8 offset:2048
ds_read_b64_tr_b16 a[24:25], v12 offset:0
v_mfma_f32_16x16x32_bf16 v[96:99], a[72:75], a[40:43], v[96:99]
ds_read_b64_tr_b16 a[26:27], v12 offset:3072
ds_read_b64_tr_b16 a[28:29], v13 offset:0
v_mfma_f32_16x16x32_bf16 v[112:115], a[76:79], a[40:43], v[112:115]
ds_read_b64_tr_b16 a[30:31], v13 offset:3072
ds_read_b128 a[8:11], v8 offset:4096
v_mfma_f32_16x16x32_bf16 v[36:39], a[56:59], a[44:47], v[36:39]
ds_read_b64_tr_b16 a[32:33], v14 offset:0
ds_read_b64_tr_b16 a[34:35], v14 offset:3072
v_mfma_f32_16x16x32_bf16 v[52:55], a[60:63], a[44:47], v[52:55]
ds_read_b128 a[12:15], v8 offset:6144
ds_read_b64_tr_b16 a[36:37], v15 offset:0
v_mfma_f32_16x16x32_bf16 v[68:71], a[64:67], a[44:47], v[68:71]
ds_read_b64_tr_b16 a[38:39], v15 offset:3072
v_mfma_f32_16x16x32_bf16 v[84:87], a[68:71], a[44:47], v[84:87]
v_mfma_f32_16x16x32_bf16 v[100:103], a[72:75], a[44:47], v[100:103]
v_mfma_f32_16x16x32_bf16 v[116:119], a[76:79], a[44:47], v[116:119]
v_mfma_f32_16x16x32_bf16 v[40:43], a[56:59], a[48:51], v[40:43]
v_mfma_f32_16x16x32_bf16 v[56:59], a[60:63], a[48:51], v[56:59]
v_mfma_f32_16x16x32_bf16 v[72:75], a[64:67], a[48:51], v[72:75]
v_mfma_f32_16x16x32_bf16 v[88:91], a[68:71], a[48:51], v[88:91]
v_mfma_f32_16x16x32_bf16 v[104:107], a[72:75], a[48:51], v[104:107]
v_mfma_f32_16x16x32_bf16 v[120:123], a[76:79], a[48:51], v[120:123]
v_mfma_f32_16x16x32_bf16 v[44:47], a[56:59], a[52:55], v[44:47]
v_mfma_f32_16x16x32_bf16 v[60:63], a[60:63], a[52:55], v[60:63]
v_mfma_f32_16x16x32_bf16 v[76:79], a[64:67], a[52:55], v[76:79]
v_mfma_f32_16x16x32_bf16 v[92:95], a[68:71], a[52:55], v[92:95]
v_mfma_f32_16x16x32_bf16 v[108:111], a[72:75], a[52:55], v[108:111]
v_mfma_f32_16x16x32_bf16 v[124:127], a[76:79], a[52:55], v[124:127]
s_waitcnt lgkmcnt(0)
s_sub_u32 s51, s51, 1
s_cmp_lg_u32 s51, 0
s_cbranch_scc1 L_t12_loop_h
s_waitcnt vmcnt(0)
v_lshlrev_b32 v18, 4, v1
s_lshl_b32 s44, s26, 3
s_lshl_b32 s45, s48, 2
s_add_u32 s44, s44, s45
s_mul_i32 s44, s44, 69632
s_mul_i32 s45, s27, 6
s_mul_i32 s46, s49, 3
s_add_u32 s45, s45, s46
s_lshl_b32 s45, s45, 10
s_add_u32 s44, s44, s45
s_add_u32 s44, s44, 0
v_add_u32 v5, s44, v18
v_cvt_pk_bf16_f32 v32, v32, v33
v_cvt_pk_bf16_f32 v33, v34, v35
v_cvt_pk_bf16_f32 v34, v48, v49
v_cvt_pk_bf16_f32 v35, v50, v51
v_pk_max_i16 v32, v32, 0
v_pk_max_i16 v33, v33, 0
v_pk_max_i16 v34, v34, 0
v_pk_max_i16 v35, v35, 0
v_cvt_pk_bf16_f32 v64, v64, v65
v_cvt_pk_bf16_f32 v65, v66, v67
v_cvt_pk_bf16_f32 v66, v80, v81
v_cvt_pk_bf16_f32 v67, v82, v83
v_pk_max_i16 v64, v64, 0
v_pk_max_i16 v65, v65, 0
v_pk_max_i16 v66, v66, 0
v_pk_max_i16 v67, v67, 0
v_cvt_pk_bf16_f32 v96, v96, v97
v_cvt_pk_bf16_f32 v97, v98, v99
v_cvt_pk_bf16_f32 v98, v112, v113
v_cvt_pk_bf16_f32 v99, v114, v115
v_pk_max_i16 v96, v96, 0
v_pk_max_i16 v97, v97, 0
v_pk_max_i16 v98, v98, 0
v_pk_max_i16 v99, v99, 0
v_cvt_pk_bf16_f32 v36, v36, v37
v_cvt_pk_bf16_f32 v37, v38, v39
v_cvt_pk_bf16_f32 v38, v52, v53
v_cvt_pk_bf16_f32 v39, v54, v55
v_pk_max_i16 v36, v36, 0
v_pk_max_i16 v37, v37, 0
v_pk_max_i16 v38, v38, 0
v_pk_max_i16 v39, v39, 0
v_cvt_pk_bf16_f32 v68, v68, v69
v_cvt_pk_bf16_f32 v69, v70, v71
v_cvt_pk_bf16_f32 v70, v84, v85
v_cvt_pk_bf16_f32 v71, v86, v87
v_pk_max_i16 v68, v68, 0
v_pk_max_i16 v69, v69, 0
v_pk_max_i16 v70, v70, 0
v_pk_max_i16 v71, v71, 0
v_cvt_pk_bf16_f32 v100, v100, v101
v_cvt_pk_bf16_f32 v101, v102, v103
v_cvt_pk_bf16_f32 v102, v116, v117
v_cvt_pk_bf16_f32 v103, v118, v119
v_pk_max_i16 v100, v100, 0
v_pk_max_i16 v101, v101, 0
v_pk_max_i16 v102, v102, 0
v_pk_max_i16 v103, v103, 0
v_cvt_pk_bf16_f32 v40, v40, v41
v_cvt_pk_bf16_f32 v41, v42, v43
v_cvt_pk_bf16_f32 v42, v56, v57
v_cvt_pk_bf16_f32 v43, v58, v59
v_pk_max_i16 v40, v40, 0
v_pk_max_i16 v41, v41, 0
v_pk_max_i16 v42, v42, 0
v_pk_max_i16 v43, v43, 0
v_cvt_pk_bf16_f32 v72, v72, v73
v_cvt_pk_bf16_f32 v73, v74, v75
v_cvt_pk_bf16_f32 v74, v88, v89
v_cvt_pk_bf16_f32 v75, v90, v91
v_pk_max_i16 v72, v72, 0
v_pk_max_i16 v73, v73, 0
v_pk_max_i16 v74, v74, 0
v_pk_max_i16 v75, v75, 0
v_cvt_pk_bf16_f32 v104, v104, v105
v_cvt_pk_bf16_f32 v105, v106, v107
v_cvt_pk_bf16_f32 v106, v120, v121
v_cvt_pk_bf16_f32 v107, v122, v123
v_pk_max_i16 v104, v104, 0
v_pk_max_i16 v105, v105, 0
v_pk_max_i16 v106, v106, 0
v_pk_max_i16 v107, v107, 0
v_cvt_pk_bf16_f32 v44, v44, v45
v_cvt_pk_bf16_f32 v45, v46, v47
v_cvt_pk_bf16_f32 v46, v60, v61
v_cvt_pk_bf16_f32 v47, v62, v63
v_pk_max_i16 v44, v44, 0
v_pk_max_i16 v45, v45, 0
v_pk_max_i16 v46, v46, 0
v_pk_max_i16 v47, v47, 0
v_cvt_pk_bf16_f32 v76, v76, v77
v_cvt_pk_bf16_f32 v77, v78, v79
v_cvt_pk_bf16_f32 v78, v92, v93
v_cvt_pk_bf16_f32 v79, v94, v95
v_pk_max_i16 v76, v76, 0
v_pk_max_i16 v77, v77, 0
v_pk_max_i16 v78, v78, 0
v_pk_max_i16 v79, v79, 0
v_cvt_pk_bf16_f32 v108, v108, v109
v_cvt_pk_bf16_f32 v109, v110, v111
v_cvt_pk_bf16_f32 v110, v124, v125
v_cvt_pk_bf16_f32 v111, v126, v127
v_pk_max_i16 v108, v108, 0
v_pk_max_i16 v109, v109, 0
v_pk_max_i16 v110, v110, 0
v_pk_max_i16 v111, v111, 0
v_add_u32 v8, 69632, v5
v_add_u32 v9, 139264, v5
v_add_u32 v10, 208896, v5
v_mov_b32 v7, v5
buffer_store_dwordx4 v[32:35], v7, s[40:43], 0 offen offset:0 sc1
buffer_store_dwordx4 v[64:67], v7, s[40:43], 0 offen offset:1024 sc1
buffer_store_dwordx4 v[96:99], v7, s[40:43], 0 offen offset:2048 sc1
buffer_store_dwordx4 v[36:39], v8, s[40:43], 0 offen offset:0 sc1
buffer_store_dwordx4 v[68:71], v8, s[40:43], 0 offen offset:1024 sc1
buffer_store_dwordx4 v[100:103], v8, s[40:43], 0 offen offset:2048 sc1
buffer_store_dwordx4 v[40:43], v9, s[40:43], 0 offen offset:0 sc1
buffer_store_dwordx4 v[72:75], v9, s[40:43], 0 offen offset:1024 sc1
buffer_store_dwordx4 v[104:107], v9, s[40:43], 0 offen offset:2048 sc1
buffer_store_dwordx4 v[44:47], v10, s[40:43], 0 offen offset:0 sc1
buffer_store_dwordx4 v[76:79], v10, s[40:43], 0 offen offset:1024 sc1
buffer_store_dwordx4 v[108:111], v10, s[40:43], 0 offen offset:2048 sc1
s_mov_b32 s58, 1069066811
v_mul_f32 v6, s58, v128
v_sub_f32 v6, 0, v6
s_mov_b32 s59, 0x42700000
v_min_f32 v6, s59, v6
v_exp_f32 v6, v6
s_nop 0
v_add_f32 v7, 1.0, v6
v_rcp_f32 v7, v7
s_lshl_b32 s44, s25, 6
v_and_b32 v5, 15, v1
v_lshlrev_b32 v5, 2, v5
v_add_u32 v5, s44, v5
v_add_u32 v5, 161024, v5
ds_write_b32 v5, v7
ds_write_b32 v5, v6 offset:256
s_waitcnt lgkmcnt(0)
v_mov_b32 v2, 161536
v_mov_b32 v3, 1
s_mov_b64 exec, 1
ds_add_u32 v2, v3 offset:44
s_mov_b64 exec, -1
s_waitcnt vmcnt(0)
s_lshl_b32 s44, s26, 10
s_lshl_b32 s45, s27, 7
s_add_u32 s44, s44, s45
s_add_u32 s44, s44, 15728640
v_mov_b32 v2, 161536
v_mov_b32 v3, 1
s_mov_b64 exec, 1
ds_add_rtn_u32 v3, v2, v3 offset:16
s_mov_b64 exec, -1
s_waitcnt lgkmcnt(0)
v_readfirstlane_b32 s46, v3
s_nop 1
s_cmp_eq_u32 s46, 3
s_cselect_b32 s47, s44, 2147483648
v_mov_b32 v2, s47
v_mov_b32 v3, s30
s_mov_b64 exec, 1
buffer_store_dword v3, v2, s[40:43], 0 offen sc1
s_mov_b64 exec, -1
L_c_t4:
s_add_u32 s44, s25, 0
s_and_b32 s44, s44, 3
s_lshr_b32 s45, s44, 1
s_lshl_b32 s45, s45, 2
s_and_b32 s46, s44, 1
s_add_u32 s45, s45, s46
s_lshl_b32 s46, s28, 1
s_add_u32 s45, s45, s46
s_lshl_b32 s46, s26, 3
s_add_u32 s47, s45, s46
s_mov_b32 s71, s47
s_mul_i32 s47, s47, 69632
s_add_u32 s47, s47, 0
v_add_u32 v8, s47, v18
s_add_u32 s44, s25, 1
s_and_b32 s44, s44, 3
s_lshr_b32 s45, s44, 1
s_lshl_b32 s45, s45, 2
s_and_b32 s46, s44, 1
s_add_u32 s45, s45, s46
s_lshl_b32 s46, s28, 1
s_add_u32 s45, s45, s46
s_lshl_b32 s46, s26, 3
s_add_u32 s47, s45, s46
s_mul_i32 s47, s47, 69632
s_add_u32 s47, s47, 0
v_add_u32 v9, s47, v18
s_add_u32 s44, s25, 2
s_and_b32 s44, s44, 3
s_lshr_b32 s45, s44, 1
s_lshl_b32 s45, s45, 2
s_and_b32 s46, s44, 1
s_add_u32 s45, s45, s46
s_lshl_b32 s46, s28, 1
s_add_u32 s45, s45, s46
s_lshl_b32 s46, s26, 3
s_add_u32 s47, s45, s46
s_mul_i32 s47, s47, 69632
s_add_u32 s47, s47, 0
v_add_u32 v10, s47, v18
s_add_u32 s44, s25, 3
s_and_b32 s44, s44, 3
s_lshr_b32 s45, s44, 1
s_lshl_b32 s45, s45, 2
s_and_b32 s46, s44, 1
s_add_u32 s45, s45, s46
s_lshl_b32 s46, s28, 1
s_add_u32 s45, s45, s46
s_lshl_b32 s46, s26, 3
s_add_u32 s47, s45, s46
s_mul_i32 s47, s47, 69632
s_add_u32 s47, s47, 0
v_add_u32 v11, s47, v18
s_mul_i32 s44, s27, 348160
s_add_u32 s44, s44, 9437184
v_add_u32 v6, s44, v18
v_add_u32 v7, 4096, v6
s_mul_i32 s52, s25, 12
s_mul_i32 s53, s25, 5
s_add_u32 s53, s53, 48
s_and_b32 s44, s29, 7
s_and_b32 s45, s27, 3
s_mul_i32 s46, s45, 3
s_add_u32 s56, s44, s46
s_cmp_ge_u32 s56, 12
s_cselect_b32 s46, 12, 0
s_sub_u32 s56, s56, s46
s_add_u32 s57, s44, s45
s_cmp_ge_u32 s57, 10
s_cselect_b32 s46, 10, 0
s_sub_u32 s57, s57, s46
s_cmp_ge_u32 s57, 5
s_cselect_b32 s46, 5, 0
s_sub_u32 s57, s57, s46
v_mov_b32 v2, 161536
s_mov_b32 s47, 1048576
L_lw_41:
ds_read_b32 v3, v2 offset:44
s_waitcnt lgkmcnt(0)
v_readfirstlane_b32 s46, v3
s_nop 1
s_cmp_ge_u32 s46, 4
s_cbranch_scc1 L_lwd_42
s_sub_u32 s47, s47, 1
s_cmp_lg_u32 s47, 0
s_cbranch_scc1 L_lw_41
L_lwd_42:
v_and_b32 v5, 15, v1
v_lshlrev_b32 v5, 2, v5
s_add_u32 s44, s25, 0
s_and_b32 s44, s44, 3
s_lshl_b32 s44, s44, 6
s_add_u32 s44, s44, 161024
v_add_u32 v16, s44, v5
ds_read_b32 v12, v16 offset:256
ds_read_b32 v19, v16
s_add_u32 s44, s25, 1
s_and_b32 s44, s44, 3
s_lshl_b32 s44, s44, 6
s_add_u32 s44, s44, 161024
v_add_u32 v16, s44, v5
ds_read_b32 v13, v16 offset:256
s_add_u32 s44, s25, 2
s_and_b32 s44, s44, 3
s_lshl_b32 s44, s44, 6
s_add_u32 s44, s44, 161024
v_add_u32 v16, s44, v5
ds_read_b32 v14, v16 offset:256
s_add_u32 s44, s25, 3
s_and_b32 s44, s44, 3
s_lshl_b32 s44, s44, 6
s_add_u32 s44, s44, 161024
v_add_u32 v16, s44, v5
ds_read_b32 v15, v16 offset:256
v_mov_b32 v2, 161536
s_mov_b32 s47, 1048576
L_lw_43:
ds_read_b32 v3, v2 offset:56
s_waitcnt lgkmcnt(0)
v_readfirstlane_b32 s46, v3
s_nop 1
s_cmp_ge_u32 s46, 3
s_cbranch_scc1 L_lwd_44
s_sub_u32 s47, s47, 1
s_cmp_lg_u32 s47, 0
s_cbranch_scc1 L_lw_43
L_lwd_44:
s_add_u32 s54, s52, s56
s_add_u32 s56, s56, 1
s_cmp_eq_u32 s56, 12
s_cselect_b32 s56, 0, s56
s_lshl_b32 s62, s54, 10
s_mul_i32 s55, s54, 5120
buffer_load_dwordx4 a[16:19], v6, s[40:43], s55 offen offset:0 sc1
buffer_load_dwordx4 a[20:23], v6, s[40:43], s55 offen offset:1024 sc1
buffer_load_dwordx4 a[24:27], v6, s[40:43], s55 offen offset:2048 sc1
buffer_load_dwordx4 a[28:31], v6, s[40:43], s55 offen offset:3072 sc1
buffer_load_dwordx4 a[32:35], v7, s[40:43], s55 offen sc1
s_add_u32 s54, s52, s56
s_add_u32 s56, s56, 1
s_cmp_eq_u32 s56, 12
s_cselect_b32 s56, 0, s56
s_lshl_b32 s63, s54, 10
s_mul_i32 s55, s54, 5120
buffer_load_dwordx4 a[52:55], v6, s[40:43], s55 offen offset:0 sc1
buffer_load_dwordx4 a[56:59], v6, s[40:43], s55 offen offset:1024 sc1
buffer_load_dwordx4 a[60:63], v6, s[40:43], s55 offen offset:2048 sc1
buffer_load_dwordx4 a[64:67], v6, s[40:43], s55 offen offset:3072 sc1
buffer_load_dwordx4 a[68:71], v7, s[40:43], s55 offen sc1
s_add_u32 s54, s52, s56
s_add_u32 s56, s56, 1
s_cmp_eq_u32 s56, 12
s_cselect_b32 s56, 0, s56
s_lshl_b32 s64, s54, 10
s_mul_i32 s55, s54, 5120
buffer_load_dwordx4 a[88:91], v6, s[40:43], s55 offen offset:0 sc1
buffer_load_dwordx4 a[92:95], v6, s[40:43], s55 offen offset:1024 sc1
buffer_load_dwordx4 v[112:115], v6, s[40:43], s55 offen offset:2048 sc1
buffer_load_dwordx4 v[116:119], v6, s[40:43], s55 offen offset:3072 sc1
buffer_load_dwordx4 v[120:123], v7, s[40:43], s55 offen sc1
v_mov_b32 v2, 161536
s_mov_b32 s47, 1048576
L_lw_45:
ds_read_b32 v3, v2 offset:8
s_waitcnt lgkmcnt(0)
v_readfirstlane_b32 s46, v3
s_nop 1
s_cmp_ge_u32 s46, 1
s_cbranch_scc1 L_lwd_46
s_sub_u32 s47, s47, 1
s_cmp_lg_u32 s47, 0
s_cbranch_scc1 L_lw_45
L_lwd_46:
buffer_load_dwordx4 a[0:3], v8, s[40:43], s62 offen sc1
buffer_load_dwordx4 a[4:7], v9, s[40:43], s62 offen sc1
buffer_load_dwordx4 a[8:11], v10, s[40:43], s62 offen sc1
buffer_load_dwordx4 a[12:15], v11, s[40:43], s62 offen sc1
buffer_load_dwordx4 a[36:39], v8, s[40:43], s63 offen sc1
buffer_load_dwordx4 a[40:43], v9, s[40:43], s63 offen sc1
buffer_load_dwordx4 a[44:47], v10, s[40:43], s63 offen sc1
buffer_load_dwordx4 a[48:51], v11, s[40:43], s63 offen sc1
buffer_load_dwordx4 a[72:75], v8, s[40:43], s64 offen sc1
buffer_load_dwordx4 a[76:79], v9, s[40:43], s64 offen sc1
buffer_load_dwordx4 a[80:83], v10, s[40:43], s64 offen sc1
buffer_load_dwordx4 a[84:87], v11, s[40:43], s64 offen sc1
s_waitcnt vmcnt(22)
s_waitcnt vmcnt(8)
v_mfma_f32_16x16x32_bf16 v[32:35], a[16:19], a[0:3], 0
v_mfma_f32_16x16x32_bf16 v[36:39], a[20:23], a[0:3], 0
v_mfma_f32_16x16x32_bf16 v[40:43], a[24:27], a[0:3], 0
v_mfma_f32_16x16x32_bf16 v[44:47], a[28:31], a[0:3], 0
v_mfma_f32_16x16x32_bf16 v[48:51], a[32:35], a[0:3], 0
v_mfma_f32_16x16x32_bf16 v[52:55], a[16:19], a[4:7], 0
v_mfma_f32_16x16x32_bf16 v[56:59], a[20:23], a[4:7], 0
v_mfma_f32_16x16x32_bf16 v[60:63], a[24:27], a[4:7], 0
v_mfma_f32_16x16x32_bf16 v[64:67], a[28:31], a[4:7], 0
v_mfma_f32_16x16x32_bf16 v[68:71], a[32:35], a[4:7], 0
v_mfma_f32_16x16x32_bf16 v[72:75], a[16:19], a[8:11], 0
v_mfma_f32_16x16x32_bf16 v[76:79], a[20:23], a[8:11], 0
v_mfma_f32_16x16x32_bf16 v[80:83], a[24:27], a[8:11], 0
v_mfma_f32_16x16x32_bf16 v[84:87], a[28:31], a[8:11], 0
v_mfma_f32_16x16x32_bf16 v[88:91], a[32:35], a[8:11], 0
v_mfma_f32_16x16x32_bf16 v[92:95], a[16:19], a[12:15], 0
v_mfma_f32_16x16x32_bf16 v[96:99], a[20:23], a[12:15], 0
v_mfma_f32_16x16x32_bf16 v[100:103], a[24:27], a[12:15], 0
v_mfma_f32_16x16x32_bf16 v[104:107], a[28:31], a[12:15], 0
v_mfma_f32_16x16x32_bf16 v[108:111], a[32:35], a[12:15], 0
s_add_u32 s54, s52, s56
s_add_u32 s56, s56, 1
s_cmp_eq_u32 s56, 12
s_cselect_b32 s56, 0, s56
s_lshl_b32 s62, s54, 10
s_mul_i32 s55, s54, 5120
buffer_load_dwordx4 a[16:19], v6, s[40:43], s55 offen offset:0 sc1
buffer_load_dwordx4 a[20:23], v6, s[40:43], s55 offen offset:1024 sc1
buffer_load_dwordx4 a[24:27], v6, s[40:43], s55 offen offset:2048 sc1
buffer_load_dwordx4 a[28:31], v6, s[40:43], s55 offen offset:3072 sc1
buffer_load_dwordx4 a[32:35], v7, s[40:43], s55 offen sc1
buffer_load_dwordx4 a[0:3], v8, s[40:43], s62 offen sc1
buffer_load_dwordx4 a[4:7], v9, s[40:43], s62 offen sc1
buffer_load_dwordx4 a[8:11], v10, s[40:43], s62 offen sc1
buffer_load_dwordx4 a[12:15], v11, s[40:43], s62 offen sc1
s_waitcnt vmcnt(13)
v_mfma_f32_16x16x32_bf16 v[32:35], a[52:55], a[36:39], v[32:35]
v_mfma_f32_16x16x32_bf16 v[36:39], a[56:59], a[36:39], v[36:39]
v_mfma_f32_16x16x32_bf16 v[40:43], a[60:63], a[36:39], v[40:43]
v_mfma_f32_16x16x32_bf16 v[44:47], a[64:67], a[36:39], v[44:47]
v_mfma_f32_16x16x32_bf16 v[48:51], a[68:71], a[36:39], v[48:51]
v_mfma_f32_16x16x32_bf16 v[52:55], a[52:55], a[40:43], v[52:55]
v_mfma_f32_16x16x32_bf16 v[56:59], a[56:59], a[40:43], v[56:59]
v_mfma_f32_16x16x32_bf16 v[60:63], a[60:63], a[40:43], v[60:63]
v_mfma_f32_16x16x32_bf16 v[64:67], a[64:67], a[40:43], v[64:67]
v_mfma_f32_16x16x32_bf16 v[68:71], a[68:71], a[40:43], v[68:71]
v_mfma_f32_16x16x32_bf16 v[72:75], a[52:55], a[44:47], v[72:75]
v_mfma_f32_16x16x32_bf16 v[76:79], a[56:59], a[44:47], v[76:79]
v_mfma_f32_16x16x32_bf16 v[80:83], a[60:63], a[44:47], v[80:83]
v_mfma_f32_16x16x32_bf16 v[84:87], a[64:67], a[44:47], v[84:87]
v_mfma_f32_16x16x32_bf16 v[88:91], a[68:71], a[44:47], v[88:91]
v_mfma_f32_16x16x32_bf16 v[92:95], a[52:55], a[48:51], v[92:95]
v_mfma_f32_16x16x32_bf16 v[96:99], a[56:59], a[48:51], v[96:99]
v_mfma_f32_16x16x32_bf16 v[100:103], a[60:63], a[48:51], v[100:103]
v_mfma_f32_16x16x32_bf16 v[104:107], a[64:67], a[48:51], v[104:107]
v_mfma_f32_16x16x32_bf16 v[108:111], a[68:71], a[48:51], v[108:111]
s_add_u32 s54, s52, s56
s_add_u32 s56, s56, 1
s_cmp_eq_u32 s56, 12
s_cselect_b32 s56, 0, s56
s_lshl_b32 s63, s54, 10
s_mul_i32 s55, s54, 5120
buffer_load_dwordx4 a[52:55], v6, s[40:43], s55 offen offset:0 sc1
buffer_load_dwordx4 a[56:59], v6, s[40:43], s55 offen offset:1024 sc1
buffer_load_dwordx4 a[60:63], v6, s[40:43], s55 offen offset:2048 sc1
buffer_load_dwordx4 a[64:67], v6, s[40:43], s55 offen offset:3072 sc1
buffer_load_dwordx4 a[68:71], v7, s[40:43], s55 offen sc1
buffer_load_dwordx4 a[36:39], v8, s[40:43], s63 offen sc1
buffer_load_dwordx4 a[40:43], v9, s[40:43], s63 offen sc1
buffer_load_dwordx4 a[44:47], v10, s[40:43], s63 offen sc1
buffer_load_dwordx4 a[48:51], v11, s[40:43], s63 offen sc1
s_waitcnt vmcnt(18)
v_mfma_f32_16x16x32_bf16 v[32:35], a[88:91], a[72:75], v[32:35]
v_mfma_f32_16x16x32_bf16 v[36:39], a[92:95], a[72:75], v[36:39]
v_mfma_f32_16x16x32_bf16 v[40:43], v[112:115], a[72:75], v[40:43]
v_mfma_f32_16x16x32_bf16 v[44:47], v[116:119], a[72:75], v[44:47]
v_mfma_f32_16x16x32_bf16 v[48:51], v[120:123], a[72:75], v[48:51]
v_mfma_f32_16x16x32_bf16 v[52:55], a[88:91], a[76:79], v[52:55]
v_mfma_f32_16x16x32_bf16 v[56:59], a[92:95], a[76:79], v[56:59]
v_mfma_f32_16x16x32_bf16 v[60:63], v[112:115], a[76:79], v[60:63]
v_mfma_f32_16x16x32_bf16 v[64:67], v[116:119], a[76:79], v[64:67]
v_mfma_f32_16x16x32_bf16 v[68:71], v[120:123], a[76:79], v[68:71]
v_mfma_f32_16x16x32_bf16 v[72:75], a[88:91], a[80:83], v[72:75]
v_mfma_f32_16x16x32_bf16 v[76:79], a[92:95], a[80:83], v[76:79]
v_mfma_f32_16x16x32_bf16 v[80:83], v[112:115], a[80:83], v[80:83]
v_mfma_f32_16x16x32_bf16 v[84:87], v[116:119], a[80:83], v[84:87]
v_mfma_f32_16x16x32_bf16 v[88:91], v[120:123], a[80:83], v[88:91]
v_mfma_f32_16x16x32_bf16 v[92:95], a[88:91], a[84:87], v[92:95]
v_mfma_f32_16x16x32_bf16 v[96:99], a[92:95], a[84:87], v[96:99]
v_mfma_f32_16x16x32_bf16 v[100:103], v[112:115], a[84:87], v[100:103]
v_mfma_f32_16x16x32_bf16 v[104:107], v[116:119], a[84:87], v[104:107]
v_mfma_f32_16x16x32_bf16 v[108:111], v[120:123], a[84:87], v[108:111]
s_add_u32 s54, s52, s56
s_add_u32 s56, s56, 1
s_cmp_eq_u32 s56, 12
s_cselect_b32 s56, 0, s56
s_lshl_b32 s64, s54, 10
s_mul_i32 s55, s54, 5120
buffer_load_dwordx4 a[88:91], v6, s[40:43], s55 offen offset:0 sc1
buffer_load_dwordx4 a[92:95], v6, s[40:43], s55 offen offset:1024 sc1
buffer_load_dwordx4 v[112:115], v6, s[40:43], s55 offen offset:2048 sc1
buffer_load_dwordx4 v[116:119], v6, s[40:43], s55 offen offset:3072 sc1
buffer_load_dwordx4 v[120:123], v7, s[40:43], s55 offen sc1
buffer_load_dwordx4 a[72:75], v8, s[40:43], s64 offen sc1
buffer_load_dwordx4 a[76:79], v9, s[40:43], s64 offen sc1
buffer_load_dwordx4 a[80:83], v10, s[40:43], s64 offen sc1
buffer_load_dwordx4 a[84:87], v11, s[40:43], s64 offen sc1
s_waitcnt vmcnt(22)
s_waitcnt vmcnt(18)
v_mfma_f32_16x16x32_bf16 v[32:35], a[16:19], a[0:3], v[32:35]
v_mfma_f32_16x16x32_bf16 v[36:39], a[20:23], a[0:3], v[36:39]
v_mfma_f32_16x16x32_bf16 v[40:43], a[24:27], a[0:3], v[40:43]
v_mfma_f32_16x16x32_bf16 v[44:47], a[28:31], a[0:3], v[44:47]
v_mfma_f32_16x16x32_bf16 v[48:51], a[32:35], a[0:3], v[48:51]
v_mfma_f32_16x16x32_bf16 v[52:55], a[16:19], a[4:7], v[52:55]
v_mfma_f32_16x16x32_bf16 v[56:59], a[20:23], a[4:7], v[56:59]
v_mfma_f32_16x16x32_bf16 v[60:63], a[24:27], a[4:7], v[60:63]
v_mfma_f32_16x16x32_bf16 v[64:67], a[28:31], a[4:7], v[64:67]
v_mfma_f32_16x16x32_bf16 v[68:71], a[32:35], a[4:7], v[68:71]
v_mfma_f32_16x16x32_bf16 v[72:75], a[16:19], a[8:11], v[72:75]
v_mfma_f32_16x16x32_bf16 v[76:79], a[20:23], a[8:11], v[76:79]
v_mfma_f32_16x16x32_bf16 v[80:83], a[24:27], a[8:11], v[80:83]
v_mfma_f32_16x16x32_bf16 v[84:87], a[28:31], a[8:11], v[84:87]
v_mfma_f32_16x16x32_bf16 v[88:91], a[32:35], a[8:11], v[88:91]
v_mfma_f32_16x16x32_bf16 v[92:95], a[16:19], a[12:15], v[92:95]
v_mfma_f32_16x16x32_bf16 v[96:99], a[20:23], a[12:15], v[96:99]
v_mfma_f32_16x16x32_bf16 v[100:103], a[24:27], a[12:15], v[100:103]
v_mfma_f32_16x16x32_bf16 v[104:107], a[28:31], a[12:15], v[104:107]
v_mfma_f32_16x16x32_bf16 v[108:111], a[32:35], a[12:15], v[108:111]
s_add_u32 s54, s52, s56
s_add_u32 s56, s56, 1
s_cmp_eq_u32 s56, 12
s_cselect_b32 s56, 0, s56
s_lshl_b32 s62, s54, 10
s_mul_i32 s55, s54, 5120
buffer_load_dwordx4 a[16:19], v6, s[40:43], s55 offen offset:0 sc1
buffer_load_dwordx4 a[20:23], v6, s[40:43], s55 offen offset:1024 sc1
buffer_load_dwordx4 a[24:27], v6, s[40:43], s55 offen offset:2048 sc1
buffer_load_dwordx4 a[28:31], v6, s[40:43], s55 offen offset:3072 sc1
buffer_load_dwordx4 a[32:35], v7, s[40:43], s55 offen sc1
buffer_load_dwordx4 a[0:3], v8, s[40:43], s62 offen sc1
buffer_load_dwordx4 a[4:7], v9, s[40:43], s62 offen sc1
buffer_load_dwordx4 a[8:11], v10, s[40:43], s62 offen sc1
buffer_load_dwordx4 a[12:15], v11, s[40:43], s62 offen sc1
s_waitcnt vmcnt(22)
s_waitcnt vmcnt(18)
v_mfma_f32_16x16x32_bf16 v[32:35], a[52:55], a[36:39], v[32:35]
v_mfma_f32_16x16x32_bf16 v[36:39], a[56:59], a[36:39], v[36:39]
v_mfma_f32_16x16x32_bf16 v[40:43], a[60:63], a[36:39], v[40:43]
v_mfma_f32_16x16x32_bf16 v[44:47], a[64:67], a[36:39], v[44:47]
v_mfma_f32_16x16x32_bf16 v[48:51], a[68:71], a[36:39], v[48:51]
v_mfma_f32_16x16x32_bf16 v[52:55], a[52:55], a[40:43], v[52:55]
v_mfma_f32_16x16x32_bf16 v[56:59], a[56:59], a[40:43], v[56:59]
v_mfma_f32_16x16x32_bf16 v[60:63], a[60:63], a[40:43], v[60:63]
v_mfma_f32_16x16x32_bf16 v[64:67], a[64:67], a[40:43], v[64:67]
v_mfma_f32_16x16x32_bf16 v[68:71], a[68:71], a[40:43], v[68:71]
v_mfma_f32_16x16x32_bf16 v[72:75], a[52:55], a[44:47], v[72:75]
v_mfma_f32_16x16x32_bf16 v[76:79], a[56:59], a[44:47], v[76:79]
v_mfma_f32_16x16x32_bf16 v[80:83], a[60:63], a[44:47], v[80:83]
v_mfma_f32_16x16x32_bf16 v[84:87], a[64:67], a[44:47], v[84:87]
v_mfma_f32_16x16x32_bf16 v[88:91], a[68:71], a[44:47], v[88:91]
v_mfma_f32_16x16x32_bf16 v[92:95], a[52:55], a[48:51], v[92:95]
v_mfma_f32_16x16x32_bf16 v[96:99], a[56:59], a[48:51], v[96:99]
v_mfma_f32_16x16x32_bf16 v[100:103], a[60:63], a[48:51], v[100:103]
v_mfma_f32_16x16x32_bf16 v[104:107], a[64:67], a[48:51], v[104:107]
v_mfma_f32_16x16x32_bf16 v[108:111], a[68:71], a[48:51], v[108:111]
s_add_u32 s54, s52, s56
s_add_u32 s56, s56, 1
s_cmp_eq_u32 s56, 12
s_cselect_b32 s56, 0, s56
s_lshl_b32 s63, s54, 10
s_mul_i32 s55, s54, 5120
buffer_load_dwordx4 a[52:55], v6, s[40:43], s55 offen offset:0 sc1
buffer_load_dwordx4 a[56:59], v6, s[40:43], s55 offen offset:1024 sc1
buffer_load_dwordx4 a[60:63], v6, s[40:43], s55 offen offset:2048 sc1
buffer_load_dwordx4 a[64:67], v6, s[40:43], s55 offen offset:3072 sc1
buffer_load_dwordx4 a[68:71], v7, s[40:43], s55 offen sc1
buffer_load_dwordx4 a[36:39], v8, s[40:43], s63 offen sc1
buffer_load_dwordx4 a[40:43], v9, s[40:43], s63 offen sc1
buffer_load_dwordx4 a[44:47], v10, s[40:43], s63 offen sc1
buffer_load_dwordx4 a[48:51], v11, s[40:43], s63 offen sc1
s_waitcnt vmcnt(22)
s_waitcnt vmcnt(18)
v_mfma_f32_16x16x32_bf16 v[32:35], a[88:91], a[72:75], v[32:35]
v_mfma_f32_16x16x32_bf16 v[36:39], a[92:95], a[72:75], v[36:39]
v_mfma_f32_16x16x32_bf16 v[40:43], v[112:115], a[72:75], v[40:43]
v_mfma_f32_16x16x32_bf16 v[44:47], v[116:119], a[72:75], v[44:47]
v_mfma_f32_16x16x32_bf16 v[48:51], v[120:123], a[72:75], v[48:51]
v_mfma_f32_16x16x32_bf16 v[52:55], a[88:91], a[76:79], v[52:55]
v_mfma_f32_16x16x32_bf16 v[56:59], a[92:95], a[76:79], v[56:59]
v_mfma_f32_16x16x32_bf16 v[60:63], v[112:115], a[76:79], v[60:63]
v_mfma_f32_16x16x32_bf16 v[64:67], v[116:119], a[76:79], v[64:67]
v_mfma_f32_16x16x32_bf16 v[68:71], v[120:123], a[76:79], v[68:71]
v_mfma_f32_16x16x32_bf16 v[72:75], a[88:91], a[80:83], v[72:75]
v_mfma_f32_16x16x32_bf16 v[76:79], a[92:95], a[80:83], v[76:79]
v_mfma_f32_16x16x32_bf16 v[80:83], v[112:115], a[80:83], v[80:83]
v_mfma_f32_16x16x32_bf16 v[84:87], v[116:119], a[80:83], v[84:87]
v_mfma_f32_16x16x32_bf16 v[88:91], v[120:123], a[80:83], v[88:91]
v_mfma_f32_16x16x32_bf16 v[92:95], a[88:91], a[84:87], v[92:95]
v_mfma_f32_16x16x32_bf16 v[96:99], a[92:95], a[84:87], v[96:99]
v_mfma_f32_16x16x32_bf16 v[100:103], v[112:115], a[84:87], v[100:103]
v_mfma_f32_16x16x32_bf16 v[104:107], v[116:119], a[84:87], v[104:107]
v_mfma_f32_16x16x32_bf16 v[108:111], v[120:123], a[84:87], v[108:111]
s_add_u32 s54, s52, s56
s_add_u32 s56, s56, 1
s_cmp_eq_u32 s56, 12
s_cselect_b32 s56, 0, s56
s_lshl_b32 s64, s54, 10
s_mul_i32 s55, s54, 5120
buffer_load_dwordx4 a[88:91], v6, s[40:43], s55 offen offset:0 sc1
buffer_load_dwordx4 a[92:95], v6, s[40:43], s55 offen offset:1024 sc1
buffer_load_dwordx4 v[112:115], v6, s[40:43], s55 offen offset:2048 sc1
buffer_load_dwordx4 v[116:119], v6, s[40:43], s55 offen offset:3072 sc1
buffer_load_dwordx4 v[120:123], v7, s[40:43], s55 offen sc1
buffer_load_dwordx4 a[72:75], v8, s[40:43], s64 offen sc1
buffer_load_dwordx4 a[76:79], v9, s[40:43], s64 offen sc1
buffer_load_dwordx4 a[80:83], v10, s[40:43], s64 offen sc1
buffer_load_dwordx4 a[84:87], v11, s[40:43], s64 offen sc1
s_waitcnt vmcnt(22)
s_waitcnt vmcnt(18)
v_mfma_f32_16x16x32_bf16 v[32:35], a[16:19], a[0:3], v[32:35]
v_mfma_f32_16x16x32_bf16 v[36:39], a[20:23], a[0:3], v[36:39]
v_mfma_f32_16x16x32_bf16 v[40:43], a[24:27], a[0:3], v[40:43]
v_mfma_f32_16x16x32_bf16 v[44:47], a[28:31], a[0:3], v[44:47]
v_mfma_f32_16x16x32_bf16 v[48:51], a[32:35], a[0:3], v[48:51]
v_mfma_f32_16x16x32_bf16 v[52:55], a[16:19], a[4:7], v[52:55]
v_mfma_f32_16x16x32_bf16 v[56:59], a[20:23], a[4:7], v[56:59]
v_mfma_f32_16x16x32_bf16 v[60:63], a[24:27], a[4:7], v[60:63]
v_mfma_f32_16x16x32_bf16 v[64:67], a[28:31], a[4:7], v[64:67]
v_mfma_f32_16x16x32_bf16 v[68:71], a[32:35], a[4:7], v[68:71]
v_mfma_f32_16x16x32_bf16 v[72:75], a[16:19], a[8:11], v[72:75]
v_mfma_f32_16x16x32_bf16 v[76:79], a[20:23], a[8:11], v[76:79]
v_mfma_f32_16x16x32_bf16 v[80:83], a[24:27], a[8:11], v[80:83]
v_mfma_f32_16x16x32_bf16 v[84:87], a[28:31], a[8:11], v[84:87]
v_mfma_f32_16x16x32_bf16 v[88:91], a[32:35], a[8:11], v[88:91]
v_mfma_f32_16x16x32_bf16 v[92:95], a[16:19], a[12:15], v[92:95]
v_mfma_f32_16x16x32_bf16 v[96:99], a[20:23], a[12:15], v[96:99]
v_mfma_f32_16x16x32_bf16 v[100:103], a[24:27], a[12:15], v[100:103]
v_mfma_f32_16x16x32_bf16 v[104:107], a[28:31], a[12:15], v[104:107]
v_mfma_f32_16x16x32_bf16 v[108:111], a[32:35], a[12:15], v[108:111]
s_add_u32 s54, s52, s56
s_add_u32 s56, s56, 1
s_cmp_eq_u32 s56, 12
s_cselect_b32 s56, 0, s56
s_lshl_b32 s62, s54, 10
s_mul_i32 s55, s54, 5120
buffer_load_dwordx4 a[16:19], v6, s[40:43], s55 offen offset:0 sc1
buffer_load_dwordx4 a[20:23], v6, s[40:43], s55 offen offset:1024 sc1
buffer_load_dwordx4 a[24:27], v6, s[40:43], s55 offen offset:2048 sc1
buffer_load_dwordx4 a[28:31], v6, s[40:43], s55 offen offset:3072 sc1
buffer_load_dwordx4 a[32:35], v7, s[40:43], s55 offen sc1
buffer_load_dwordx4 a[0:3], v8, s[40:43], s62 offen sc1
buffer_load_dwordx4 a[4:7], v9, s[40:43], s62 offen sc1
buffer_load_dwordx4 a[8:11], v10, s[40:43], s62 offen sc1
buffer_load_dwordx4 a[12:15], v11, s[40:43], s62 offen sc1
s_waitcnt vmcnt(22)
s_waitcnt vmcnt(18)
v_mfma_f32_16x16x32_bf16 v[32:35], a[52:55], a[36:39], v[32:35]
v_mfma_f32_16x16x32_bf16 v[36:39], a[56:59], a[36:39], v[36:39]
v_mfma_f32_16x16x32_bf16 v[40:43], a[60:63], a[36:39], v[40:43]
v_mfma_f32_16x16x32_bf16 v[44:47], a[64:67], a[36:39], v[44:47]
v_mfma_f32_16x16x32_bf16 v[48:51], a[68:71], a[36:39], v[48:51]
v_mfma_f32_16x16x32_bf16 v[52:55], a[52:55], a[40:43], v[52:55]
v_mfma_f32_16x16x32_bf16 v[56:59], a[56:59], a[40:43], v[56:59]
v_mfma_f32_16x16x32_bf16 v[60:63], a[60:63], a[40:43], v[60:63]
v_mfma_f32_16x16x32_bf16 v[64:67], a[64:67], a[40:43], v[64:67]
v_mfma_f32_16x16x32_bf16 v[68:71], a[68:71], a[40:43], v[68:71]
v_mfma_f32_16x16x32_bf16 v[72:75], a[52:55], a[44:47], v[72:75]
v_mfma_f32_16x16x32_bf16 v[76:79], a[56:59], a[44:47], v[76:79]
v_mfma_f32_16x16x32_bf16 v[80:83], a[60:63], a[44:47], v[80:83]
v_mfma_f32_16x16x32_bf16 v[84:87], a[64:67], a[44:47], v[84:87]
v_mfma_f32_16x16x32_bf16 v[88:91], a[68:71], a[44:47], v[88:91]
v_mfma_f32_16x16x32_bf16 v[92:95], a[52:55], a[48:51], v[92:95]
v_mfma_f32_16x16x32_bf16 v[96:99], a[56:59], a[48:51], v[96:99]
v_mfma_f32_16x16x32_bf16 v[100:103], a[60:63], a[48:51], v[100:103]
v_mfma_f32_16x16x32_bf16 v[104:107], a[64:67], a[48:51], v[104:107]
v_mfma_f32_16x16x32_bf16 v[108:111], a[68:71], a[48:51], v[108:111]
s_add_u32 s54, s52, s56
s_add_u32 s56, s56, 1
s_cmp_eq_u32 s56, 12
s_cselect_b32 s56, 0, s56
s_lshl_b32 s63, s54, 10
s_mul_i32 s55, s54, 5120
buffer_load_dwordx4 a[52:55], v6, s[40:43], s55 offen offset:0 sc1
buffer_load_dwordx4 a[56:59], v6, s[40:43], s55 offen offset:1024 sc1
buffer_load_dwordx4 a[60:63], v6, s[40:43], s55 offen offset:2048 sc1
buffer_load_dwordx4 a[64:67], v6, s[40:43], s55 offen offset:3072 sc1
buffer_load_dwordx4 a[68:71], v7, s[40:43], s55 offen sc1
buffer_load_dwordx4 a[36:39], v8, s[40:43], s63 offen sc1
buffer_load_dwordx4 a[40:43], v9, s[40:43], s63 offen sc1
buffer_load_dwordx4 a[44:47], v10, s[40:43], s63 offen sc1
buffer_load_dwordx4 a[48:51], v11, s[40:43], s63 offen sc1
s_waitcnt vmcnt(22)
s_waitcnt vmcnt(18)
v_mfma_f32_16x16x32_bf16 v[32:35], a[88:91], a[72:75], v[32:35]
v_mfma_f32_16x16x32_bf16 v[36:39], a[92:95], a[72:75], v[36:39]
v_mfma_f32_16x16x32_bf16 v[40:43], v[112:115], a[72:75], v[40:43]
v_mfma_f32_16x16x32_bf16 v[44:47], v[116:119], a[72:75], v[44:47]
v_mfma_f32_16x16x32_bf16 v[48:51], v[120:123], a[72:75], v[48:51]
v_mfma_f32_16x16x32_bf16 v[52:55], a[88:91], a[76:79], v[52:55]
v_mfma_f32_16x16x32_bf16 v[56:59], a[92:95], a[76:79], v[56:59]
v_mfma_f32_16x16x32_bf16 v[60:63], v[112:115], a[76:79], v[60:63]
v_mfma_f32_16x16x32_bf16 v[64:67], v[116:119], a[76:79], v[64:67]
v_mfma_f32_16x16x32_bf16 v[68:71], v[120:123], a[76:79], v[68:71]
v_mfma_f32_16x16x32_bf16 v[72:75], a[88:91], a[80:83], v[72:75]
v_mfma_f32_16x16x32_bf16 v[76:79], a[92:95], a[80:83], v[76:79]
v_mfma_f32_16x16x32_bf16 v[80:83], v[112:115], a[80:83], v[80:83]
v_mfma_f32_16x16x32_bf16 v[84:87], v[116:119], a[80:83], v[84:87]
v_mfma_f32_16x16x32_bf16 v[88:91], v[120:123], a[80:83], v[88:91]
v_mfma_f32_16x16x32_bf16 v[92:95], a[88:91], a[84:87], v[92:95]
v_mfma_f32_16x16x32_bf16 v[96:99], a[92:95], a[84:87], v[96:99]
v_mfma_f32_16x16x32_bf16 v[100:103], v[112:115], a[84:87], v[100:103]
v_mfma_f32_16x16x32_bf16 v[104:107], v[116:119], a[84:87], v[104:107]
v_mfma_f32_16x16x32_bf16 v[108:111], v[120:123], a[84:87], v[108:111]
s_add_u32 s54, s52, s56
s_add_u32 s56, s56, 1
s_cmp_eq_u32 s56, 12
s_cselect_b32 s56, 0, s56
s_lshl_b32 s64, s54, 10
s_mul_i32 s55, s54, 5120
buffer_load_dwordx4 a[88:91], v6, s[40:43], s55 offen offset:0 sc1
buffer_load_dwordx4 a[92:95], v6, s[40:43], s55 offen offset:1024 sc1
buffer_load_dwordx4 v[112:115], v6, s[40:43], s55 offen offset:2048 sc1
buffer_load_dwordx4 v[116:119], v6, s[40:43], s55 offen offset:3072 sc1
buffer_load_dwordx4 v[120:123], v7, s[40:43], s55 offen sc1
buffer_load_dwordx4 a[72:75], v8, s[40:43], s64 offen sc1
buffer_load_dwordx4 a[76:79], v9, s[40:43], s64 offen sc1
buffer_load_dwordx4 a[80:83], v10, s[40:43], s64 offen sc1
buffer_load_dwordx4 a[84:87], v11, s[40:43], s64 offen sc1
s_waitcnt vmcnt(22)
s_waitcnt vmcnt(18)
v_mfma_f32_16x16x32_bf16 v[32:35], a[16:19], a[0:3], v[32:35]
v_mfma_f32_16x16x32_bf16 v[36:39], a[20:23], a[0:3], v[36:39]
v_mfma_f32_16x16x32_bf16 v[40:43], a[24:27], a[0:3], v[40:43]
v_mfma_f32_16x16x32_bf16 v[44:47], a[28:31], a[0:3], v[44:47]
v_mfma_f32_16x16x32_bf16 v[48:51], a[32:35], a[0:3], v[48:51]
v_mfma_f32_16x16x32_bf16 v[52:55], a[16:19], a[4:7], v[52:55]
v_mfma_f32_16x16x32_bf16 v[56:59], a[20:23], a[4:7], v[56:59]
v_mfma_f32_16x16x32_bf16 v[60:63], a[24:27], a[4:7], v[60:63]
v_mfma_f32_16x16x32_bf16 v[64:67], a[28:31], a[4:7], v[64:67]
v_mfma_f32_16x16x32_bf16 v[68:71], a[32:35], a[4:7], v[68:71]
v_mfma_f32_16x16x32_bf16 v[72:75], a[16:19], a[8:11], v[72:75]
v_mfma_f32_16x16x32_bf16 v[76:79], a[20:23], a[8:11], v[76:79]
v_mfma_f32_16x16x32_bf16 v[80:83], a[24:27], a[8:11], v[80:83]
v_mfma_f32_16x16x32_bf16 v[84:87], a[28:31], a[8:11], v[84:87]
v_mfma_f32_16x16x32_bf16 v[88:91], a[32:35], a[8:11], v[88:91]
v_mfma_f32_16x16x32_bf16 v[92:95], a[16:19], a[12:15], v[92:95]
v_mfma_f32_16x16x32_bf16 v[96:99], a[20:23], a[12:15], v[96:99]
v_mfma_f32_16x16x32_bf16 v[100:103], a[24:27], a[12:15], v[100:103]
v_mfma_f32_16x16x32_bf16 v[104:107], a[28:31], a[12:15], v[104:107]
v_mfma_f32_16x16x32_bf16 v[108:111], a[32:35], a[12:15], v[108:111]
s_add_u32 s54, s53, s57
s_add_u32 s57, s57, 1
s_cmp_eq_u32 s57, 5
s_cselect_b32 s57, 0, s57
s_lshl_b32 s62, s54, 10
s_mul_i32 s55, s54, 5120
buffer_load_dwordx4 a[16:19], v6, s[40:43], s55 offen offset:0 sc1
buffer_load_dwordx4 a[20:23], v6, s[40:43], s55 offen offset:1024 sc1
buffer_load_dwordx4 a[24:27], v6, s[40:43], s55 offen offset:2048 sc1
buffer_load_dwordx4 a[28:31], v6, s[40:43], s55 offen offset:3072 sc1
buffer_load_dwordx4 a[32:35], v7, s[40:43], s55 offen sc1
s_waitcnt vmcnt(18)
s_waitcnt vmcnt(14)
v_mfma_f32_16x16x32_bf16 v[32:35], a[52:55], a[36:39], v[32:35]
v_mfma_f32_16x16x32_bf16 v[36:39], a[56:59], a[36:39], v[36:39]
v_mfma_f32_16x16x32_bf16 v[40:43], a[60:63], a[36:39], v[40:43]
v_mfma_f32_16x16x32_bf16 v[44:47], a[64:67], a[36:39], v[44:47]
v_mfma_f32_16x16x32_bf16 v[48:51], a[68:71], a[36:39], v[48:51]
v_mfma_f32_16x16x32_bf16 v[52:55], a[52:55], a[40:43], v[52:55]
v_mfma_f32_16x16x32_bf16 v[56:59], a[56:59], a[40:43], v[56:59]
v_mfma_f32_16x16x32_bf16 v[60:63], a[60:63], a[40:43], v[60:63]
v_mfma_f32_16x16x32_bf16 v[64:67], a[64:67], a[40:43], v[64:67]
v_mfma_f32_16x16x32_bf16 v[68:71], a[68:71], a[40:43], v[68:71]
v_mfma_f32_16x16x32_bf16 v[72:75], a[52:55], a[44:47], v[72:75]
v_mfma_f32_16x16x32_bf16 v[76:79], a[56:59], a[44:47], v[76:79]
v_mfma_f32_16x16x32_bf16 v[80:83], a[60:63], a[44:47], v[80:83]
v_mfma_f32_16x16x32_bf16 v[84:87], a[64:67], a[44:47], v[84:87]
v_mfma_f32_16x16x32_bf16 v[88:91], a[68:71], a[44:47], v[88:91]
v_mfma_f32_16x16x32_bf16 v[92:95], a[52:55], a[48:51], v[92:95]
v_mfma_f32_16x16x32_bf16 v[96:99], a[56:59], a[48:51], v[96:99]
v_mfma_f32_16x16x32_bf16 v[100:103], a[60:63], a[48:51], v[100:103]
v_mfma_f32_16x16x32_bf16 v[104:107], a[64:67], a[48:51], v[104:107]
v_mfma_f32_16x16x32_bf16 v[108:111], a[68:71], a[48:51], v[108:111]
s_add_u32 s54, s53, s57
s_add_u32 s57, s57, 1
s_cmp_eq_u32 s57, 5
s_cselect_b32 s57, 0, s57
s_lshl_b32 s63, s54, 10
s_mul_i32 s55, s54, 5120
buffer_load_dwordx4 a[52:55], v6, s[40:43], s55 offen offset:0 sc1
buffer_load_dwordx4 a[56:59], v6, s[40:43], s55 offen offset:1024 sc1
buffer_load_dwordx4 a[60:63], v6, s[40:43], s55 offen offset:2048 sc1
buffer_load_dwordx4 a[64:67], v6, s[40:43], s55 offen offset:3072 sc1
buffer_load_dwordx4 a[68:71], v7, s[40:43], s55 offen sc1
s_waitcnt vmcnt(14)
s_waitcnt vmcnt(10)
v_mfma_f32_16x16x32_bf16 v[32:35], a[88:91], a[72:75], v[32:35]
v_mfma_f32_16x16x32_bf16 v[36:39], a[92:95], a[72:75], v[36:39]
v_mfma_f32_16x16x32_bf16 v[40:43], v[112:115], a[72:75], v[40:43]
v_mfma_f32_16x16x32_bf16 v[44:47], v[116:119], a[72:75], v[44:47]
v_mfma_f32_16x16x32_bf16 v[48:51], v[120:123], a[72:75], v[48:51]
v_mfma_f32_16x16x32_bf16 v[52:55], a[88:91], a[76:79], v[52:55]
v_mfma_f32_16x16x32_bf16 v[56:59], a[92:95], a[76:79], v[56:59]
v_mfma_f32_16x16x32_bf16 v[60:63], v[112:115], a[76:79], v[60:63]
v_mfma_f32_16x16x32_bf16 v[64:67], v[116:119], a[76:79], v[64:67]
v_mfma_f32_16x16x32_bf16 v[68:71], v[120:123], a[76:79], v[68:71]
v_mfma_f32_16x16x32_bf16 v[72:75], a[88:91], a[80:83], v[72:75]
v_mfma_f32_16x16x32_bf16 v[76:79], a[92:95], a[80:83], v[76:79]
v_mfma_f32_16x16x32_bf16 v[80:83], v[112:115], a[80:83], v[80:83]
v_mfma_f32_16x16x32_bf16 v[84:87], v[116:119], a[80:83], v[84:87]
v_mfma_f32_16x16x32_bf16 v[88:91], v[120:123], a[80:83], v[88:91]
v_mfma_f32_16x16x32_bf16 v[92:95], a[88:91], a[84:87], v[92:95]
v_mfma_f32_16x16x32_bf16 v[96:99], a[92:95], a[84:87], v[96:99]
v_mfma_f32_16x16x32_bf16 v[100:103], v[112:115], a[84:87], v[100:103]
v_mfma_f32_16x16x32_bf16 v[104:107], v[116:119], a[84:87], v[104:107]
v_mfma_f32_16x16x32_bf16 v[108:111], v[120:123], a[84:87], v[108:111]
s_add_u32 s54, s53, s57
s_add_u32 s57, s57, 1
s_cmp_eq_u32 s57, 5
s_cselect_b32 s57, 0, s57
s_lshl_b32 s64, s54, 10
s_mul_i32 s55, s54, 5120
buffer_load_dwordx4 a[88:91], v6, s[40:43], s55 offen offset:0 sc1
buffer_load_dwordx4 a[92:95], v6, s[40:43], s55 offen offset:1024 sc1
buffer_load_dwordx4 v[112:115], v6, s[40:43], s55 offen offset:2048 sc1
buffer_load_dwordx4 v[116:119], v6, s[40:43], s55 offen offset:3072 sc1
buffer_load_dwordx4 v[120:123], v7, s[40:43], s55 offen sc1
v_mov_b32 v2, 161536
s_mov_b32 s47, 1048576
L_lw_47:
ds_read_b32 v3, v2 offset:12
s_waitcnt lgkmcnt(0)
v_readfirstlane_b32 s46, v3
s_nop 1
s_cmp_ge_u32 s46, 1
s_cbranch_scc1 L_lwd_48
s_sub_u32 s47, s47, 1
s_cmp_lg_u32 s47, 0
s_cbranch_scc1 L_lw_47
L_lwd_48:
buffer_load_dwordx4 a[0:3], v8, s[40:43], s62 offen sc1
buffer_load_dwordx4 a[4:7], v9, s[40:43], s62 offen sc1
buffer_load_dwordx4 a[8:11], v10, s[40:43], s62 offen sc1
buffer_load_dwordx4 a[12:15], v11, s[40:43], s62 offen sc1
buffer_load_dwordx4 a[36:39], v8, s[40:43], s63 offen sc1
buffer_load_dwordx4 a[40:43], v9, s[40:43], s63 offen sc1
buffer_load_dwordx4 a[44:47], v10, s[40:43], s63 offen sc1
buffer_load_dwordx4 a[48:51], v11, s[40:43], s63 offen sc1
buffer_load_dwordx4 a[72:75], v8, s[40:43], s64 offen sc1
buffer_load_dwordx4 a[76:79], v9, s[40:43], s64 offen sc1
buffer_load_dwordx4 a[80:83], v10, s[40:43], s64 offen sc1
buffer_load_dwordx4 a[84:87], v11, s[40:43], s64 offen sc1
s_waitcnt vmcnt(22)
s_waitcnt vmcnt(8)
v_mul_f32 v32, v32, v12
v_mul_f32 v33, v33, v12
v_mul_f32 v34, v34, v12
v_mul_f32 v35, v35, v12
v_mul_f32 v36, v36, v12
v_mul_f32 v37, v37, v12
v_mul_f32 v38, v38, v12
v_mul_f32 v39, v39, v12
v_mul_f32 v40, v40, v12
v_mul_f32 v41, v41, v12
v_mul_f32 v42, v42, v12
v_mul_f32 v43, v43, v12
v_mul_f32 v44, v44, v12
v_mul_f32 v45, v45, v12
v_mul_f32 v46, v46, v12
v_mul_f32 v47, v47, v12
v_mul_f32 v48, v48, v12
v_mul_f32 v49, v49, v12
v_mul_f32 v50, v50, v12
v_mul_f32 v51, v51, v12
v_mul_f32 v52, v52, v13
v_mul_f32 v53, v53, v13
v_mul_f32 v54, v54, v13
v_mul_f32 v55, v55, v13
v_mul_f32 v56, v56, v13
v_mul_f32 v57, v57, v13
v_mul_f32 v58, v58, v13
v_mul_f32 v59, v59, v13
v_mul_f32 v60, v60, v13
v_mul_f32 v61, v61, v13
v_mul_f32 v62, v62, v13
v_mul_f32 v63, v63, v13
v_mul_f32 v64, v64, v13
v_mul_f32 v65, v65, v13
v_mul_f32 v66, v66, v13
v_mul_f32 v67, v67, v13
v_mul_f32 v68, v68, v13
v_mul_f32 v69, v69, v13
v_mul_f32 v70, v70, v13
v_mul_f32 v71, v71, v13
v_mul_f32 v72, v72, v14
v_mul_f32 v73, v73, v14
v_mul_f32 v74, v74, v14
v_mul_f32 v75, v75, v14
v_mul_f32 v76, v76, v14
v_mul_f32 v77, v77, v14
v_mul_f32 v78, v78, v14
v_mul_f32 v79, v79, v14
v_mul_f32 v80, v80, v14
v_mul_f32 v81, v81, v14
v_mul_f32 v82, v82, v14
v_mul_f32 v83, v83, v14
v_mul_f32 v84, v84, v14
v_mul_f32 v85, v85, v14
v_mul_f32 v86, v86, v14
v_mul_f32 v87, v87, v14
v_mul_f32 v88, v88, v14
v_mul_f32 v89, v89, v14
v_mul_f32 v90, v90, v14
v_mul_f32 v91, v91, v14
v_mul_f32 v92, v92, v15
v_mul_f32 v93, v93, v15
v_mul_f32 v94, v94, v15
v_mul_f32 v95, v95, v15
v_mul_f32 v96, v96, v15
v_mul_f32 v97, v97, v15
v_mul_f32 v98, v98, v15
v_mul_f32 v99, v99, v15
v_mul_f32 v100, v100, v15
v_mul_f32 v101, v101, v15
v_mul_f32 v102, v102, v15
v_mul_f32 v103, v103, v15
v_mul_f32 v104, v104, v15
v_mul_f32 v105, v105, v15
v_mul_f32 v106, v106, v15
v_mul_f32 v107, v107, v15
v_mul_f32 v108, v108, v15
v_mul_f32 v109, v109, v15
v_mul_f32 v110, v110, v15
v_mul_f32 v111, v111, v15
v_mfma_f32_16x16x32_bf16 v[32:35], a[16:19], a[0:3], v[32:35]
v_mfma_f32_16x16x32_bf16 v[36:39], a[20:23], a[0:3], v[36:39]
v_mfma_f32_16x16x32_bf16 v[40:43], a[24:27], a[0:3], v[40:43]
v_mfma_f32_16x16x32_bf16 v[44:47], a[28:31], a[0:3], v[44:47]
v_mfma_f32_16x16x32_bf16 v[48:51], a[32:35], a[0:3], v[48:51]
v_mfma_f32_16x16x32_bf16 v[52:55], a[16:19], a[4:7], v[52:55]
v_mfma_f32_16x16x32_bf16 v[56:59], a[20:23], a[4:7], v[56:59]
v_mfma_f32_16x16x32_bf16 v[60:63], a[24:27], a[4:7], v[60:63]
v_mfma_f32_16x16x32_bf16 v[64:67], a[28:31], a[4:7], v[64:67]
v_mfma_f32_16x16x32_bf16 v[68:71], a[32:35], a[4:7], v[68:71]
v_mfma_f32_16x16x32_bf16 v[72:75], a[16:19], a[8:11], v[72:75]
v_mfma_f32_16x16x32_bf16 v[76:79], a[20:23], a[8:11], v[76:79]
v_mfma_f32_16x16x32_bf16 v[80:83], a[24:27], a[8:11], v[80:83]
v_mfma_f32_16x16x32_bf16 v[84:87], a[28:31], a[8:11], v[84:87]
v_mfma_f32_16x16x32_bf16 v[88:91], a[32:35], a[8:11], v[88:91]
v_mfma_f32_16x16x32_bf16 v[92:95], a[16:19], a[12:15], v[92:95]
v_mfma_f32_16x16x32_bf16 v[96:99], a[20:23], a[12:15], v[96:99]
v_mfma_f32_16x16x32_bf16 v[100:103], a[24:27], a[12:15], v[100:103]
v_mfma_f32_16x16x32_bf16 v[104:107], a[28:31], a[12:15], v[104:107]
v_mfma_f32_16x16x32_bf16 v[108:111], a[32:35], a[12:15], v[108:111]
s_add_u32 s54, s53, s57
s_add_u32 s57, s57, 1
s_cmp_eq_u32 s57, 5
s_cselect_b32 s57, 0, s57
s_lshl_b32 s62, s54, 10
s_mul_i32 s55, s54, 5120
buffer_load_dwordx4 a[16:19], v6, s[40:43], s55 offen offset:0 sc1
buffer_load_dwordx4 a[20:23], v6, s[40:43], s55 offen offset:1024 sc1
buffer_load_dwordx4 a[24:27], v6, s[40:43], s55 offen offset:2048 sc1
buffer_load_dwordx4 a[28:31], v6, s[40:43], s55 offen offset:3072 sc1
buffer_load_dwordx4 a[32:35], v7, s[40:43], s55 offen sc1
buffer_load_dwordx4 a[0:3], v8, s[40:43], s62 offen sc1
buffer_load_dwordx4 a[4:7], v9, s[40:43], s62 offen sc1
buffer_load_dwordx4 a[8:11], v10, s[40:43], s62 offen sc1
buffer_load_dwordx4 a[12:15], v11, s[40:43], s62 offen sc1
s_waitcnt vmcnt(13)
v_mfma_f32_16x16x32_bf16 v[32:35], a[52:55], a[36:39], v[32:35]
v_mfma_f32_16x16x32_bf16 v[36:39], a[56:59], a[36:39], v[36:39]
v_mfma_f32_16x16x32_bf16 v[40:43], a[60:63], a[36:39], v[40:43]
v_mfma_f32_16x16x32_bf16 v[44:47], a[64:67], a[36:39], v[44:47]
v_mfma_f32_16x16x32_bf16 v[48:51], a[68:71], a[36:39], v[48:51]
v_mfma_f32_16x16x32_bf16 v[52:55], a[52:55], a[40:43], v[52:55]
v_mfma_f32_16x16x32_bf16 v[56:59], a[56:59], a[40:43], v[56:59]
v_mfma_f32_16x16x32_bf16 v[60:63], a[60:63], a[40:43], v[60:63]
v_mfma_f32_16x16x32_bf16 v[64:67], a[64:67], a[40:43], v[64:67]
v_mfma_f32_16x16x32_bf16 v[68:71], a[68:71], a[40:43], v[68:71]
v_mfma_f32_16x16x32_bf16 v[72:75], a[52:55], a[44:47], v[72:75]
v_mfma_f32_16x16x32_bf16 v[76:79], a[56:59], a[44:47], v[76:79]
v_mfma_f32_16x16x32_bf16 v[80:83], a[60:63], a[44:47], v[80:83]
v_mfma_f32_16x16x32_bf16 v[84:87], a[64:67], a[44:47], v[84:87]
v_mfma_f32_16x16x32_bf16 v[88:91], a[68:71], a[44:47], v[88:91]
v_mfma_f32_16x16x32_bf16 v[92:95], a[52:55], a[48:51], v[92:95]
v_mfma_f32_16x16x32_bf16 v[96:99], a[56:59], a[48:51], v[96:99]
v_mfma_f32_16x16x32_bf16 v[100:103], a[60:63], a[48:51], v[100:103]
v_mfma_f32_16x16x32_bf16 v[104:107], a[64:67], a[48:51], v[104:107]
v_mfma_f32_16x16x32_bf16 v[108:111], a[68:71], a[48:51], v[108:111]
s_add_u32 s54, s53, s57
s_add_u32 s57, s57, 1
s_cmp_eq_u32 s57, 5
s_cselect_b32 s57, 0, s57
s_lshl_b32 s63, s54, 10
s_mul_i32 s55, s54, 5120
buffer_load_dwordx4 a[52:55], v6, s[40:43], s55 offen offset:0 sc1
buffer_load_dwordx4 a[56:59], v6, s[40:43], s55 offen offset:1024 sc1
buffer_load_dwordx4 a[60:63], v6, s[40:43], s55 offen offset:2048 sc1
buffer_load_dwordx4 a[64:67], v6, s[40:43], s55 offen offset:3072 sc1
buffer_load_dwordx4 a[68:71], v7, s[40:43], s55 offen sc1
buffer_load_dwordx4 a[36:39], v8, s[40:43], s63 offen sc1
buffer_load_dwordx4 a[40:43], v9, s[40:43], s63 offen sc1
buffer_load_dwordx4 a[44:47], v10, s[40:43], s63 offen sc1
buffer_load_dwordx4 a[48:51], v11, s[40:43], s63 offen sc1
s_waitcnt vmcnt(18)
v_mfma_f32_16x16x32_bf16 v[32:35], a[88:91], a[72:75], v[32:35]
v_mfma_f32_16x16x32_bf16 v[36:39], a[92:95], a[72:75], v[36:39]
v_mfma_f32_16x16x32_bf16 v[40:43], v[112:115], a[72:75], v[40:43]
v_mfma_f32_16x16x32_bf16 v[44:47], v[116:119], a[72:75], v[44:47]
v_mfma_f32_16x16x32_bf16 v[48:51], v[120:123], a[72:75], v[48:51]
v_mfma_f32_16x16x32_bf16 v[52:55], a[88:91], a[76:79], v[52:55]
v_mfma_f32_16x16x32_bf16 v[56:59], a[92:95], a[76:79], v[56:59]
v_mfma_f32_16x16x32_bf16 v[60:63], v[112:115], a[76:79], v[60:63]
v_mfma_f32_16x16x32_bf16 v[64:67], v[116:119], a[76:79], v[64:67]
v_mfma_f32_16x16x32_bf16 v[68:71], v[120:123], a[76:79], v[68:71]
v_mfma_f32_16x16x32_bf16 v[72:75], a[88:91], a[80:83], v[72:75]
v_mfma_f32_16x16x32_bf16 v[76:79], a[92:95], a[80:83], v[76:79]
v_mfma_f32_16x16x32_bf16 v[80:83], v[112:115], a[80:83], v[80:83]
v_mfma_f32_16x16x32_bf16 v[84:87], v[116:119], a[80:83], v[84:87]
v_mfma_f32_16x16x32_bf16 v[88:91], v[120:123], a[80:83], v[88:91]
v_mfma_f32_16x16x32_bf16 v[92:95], a[88:91], a[84:87], v[92:95]
v_mfma_f32_16x16x32_bf16 v[96:99], a[92:95], a[84:87], v[96:99]
v_mfma_f32_16x16x32_bf16 v[100:103], v[112:115], a[84:87], v[100:103]
v_mfma_f32_16x16x32_bf16 v[104:107], v[116:119], a[84:87], v[104:107]
v_mfma_f32_16x16x32_bf16 v[108:111], v[120:123], a[84:87], v[108:111]
s_waitcnt vmcnt(13)
s_waitcnt vmcnt(9)
v_mfma_f32_16x16x32_bf16 v[32:35], a[16:19], a[0:3], v[32:35]
v_mfma_f32_16x16x32_bf16 v[36:39], a[20:23], a[0:3], v[36:39]
v_mfma_f32_16x16x32_bf16 v[40:43], a[24:27], a[0:3], v[40:43]
v_mfma_f32_16x16x32_bf16 v[44:47], a[28:31], a[0:3], v[44:47]
v_mfma_f32_16x16x32_bf16 v[48:51], a[32:35], a[0:3], v[48:51]
v_mfma_f32_16x16x32_bf16 v[52:55], a[16:19], a[4:7], v[52:55]
v_mfma_f32_16x16x32_bf16 v[56:59], a[20:23], a[4:7], v[56:59]
v_mfma_f32_16x16x32_bf16 v[60:63], a[24:27], a[4:7], v[60:63]
v_mfma_f32_16x16x32_bf16 v[64:67], a[28:31], a[4:7], v[64:67]
v_mfma_f32_16x16x32_bf16 v[68:71], a[32:35], a[4:7], v[68:71]
v_mfma_f32_16x16x32_bf16 v[72:75], a[16:19], a[8:11], v[72:75]
v_mfma_f32_16x16x32_bf16 v[76:79], a[20:23], a[8:11], v[76:79]
v_mfma_f32_16x16x32_bf16 v[80:83], a[24:27], a[8:11], v[80:83]
v_mfma_f32_16x16x32_bf16 v[84:87], a[28:31], a[8:11], v[84:87]
v_mfma_f32_16x16x32_bf16 v[88:91], a[32:35], a[8:11], v[88:91]
v_mfma_f32_16x16x32_bf16 v[92:95], a[16:19], a[12:15], v[92:95]
v_mfma_f32_16x16x32_bf16 v[96:99], a[20:23], a[12:15], v[96:99]
v_mfma_f32_16x16x32_bf16 v[100:103], a[24:27], a[12:15], v[100:103]
v_mfma_f32_16x16x32_bf16 v[104:107], a[28:31], a[12:15], v[104:107]
v_mfma_f32_16x16x32_bf16 v[108:111], a[32:35], a[12:15], v[108:111]
s_waitcnt vmcnt(4)
s_waitcnt vmcnt(0)
v_mfma_f32_16x16x32_bf16 v[32:35], a[52:55], a[36:39], v[32:35]
v_mfma_f32_16x16x32_bf16 v[36:39], a[56:59], a[36:39], v[36:39]
v_mfma_f32_16x16x32_bf16 v[40:43], a[60:63], a[36:39], v[40:43]
v_mfma_f32_16x16x32_bf16 v[44:47], a[64:67], a[36:39], v[44:47]
v_mfma_f32_16x16x32_bf16 v[48:51], a[68:71], a[36:39], v[48:51]
v_mfma_f32_16x16x32_bf16 v[52:55], a[52:55], a[40:43], v[52:55]
v_mfma_f32_16x16x32_bf16 v[56:59], a[56:59], a[40:43], v[56:59]
v_mfma_f32_16x16x32_bf16 v[60:63], a[60:63], a[40:43], v[60:63]
v_mfma_f32_16x16x32_bf16 v[64:67], a[64:67], a[40:43], v[64:67]
v_mfma_f32_16x16x32_bf16 v[68:71], a[68:71], a[40:43], v[68:71]
v_mfma_f32_16x16x32_bf16 v[72:75], a[52:55], a[44:47], v[72:75]
v_mfma_f32_16x16x32_bf16 v[76:79], a[56:59], a[44:47], v[76:79]
v_mfma_f32_16x16x32_bf16 v[80:83], a[60:63], a[44:47], v[80:83]
v_mfma_f32_16x16x32_bf16 v[84:87], a[64:67], a[44:47], v[84:87]
v_mfma_f32_16x16x32_bf16 v[88:91], a[68:71], a[44:47], v[88:91]
v_mfma_f32_16x16x32_bf16 v[92:95], a[52:55], a[48:51], v[92:95]
v_mfma_f32_16x16x32_bf16 v[96:99], a[56:59], a[48:51], v[96:99]
v_mfma_f32_16x16x32_bf16 v[100:103], a[60:63], a[48:51], v[100:103]
v_mfma_f32_16x16x32_bf16 v[104:107], a[64:67], a[48:51], v[104:107]
v_mfma_f32_16x16x32_bf16 v[108:111], a[68:71], a[48:51], v[108:111]
s_add_u32 s44, s25, 1
s_and_b32 s44, s44, 3
s_mul_i32 s44, s44, 3
s_add_u32 s44, s44, 0
s_mul_i32 s45, s44, 5120
v_add_u32 v5, s45, v18
ds_write_b128 v5, v[52:55] offset:0
ds_write_b128 v5, v[56:59] offset:1024
ds_write_b128 v5, v[60:63] offset:2048
ds_write_b128 v5, v[64:67] offset:3072
ds_write_b128 v5, v[68:71] offset:4096
s_add_u32 s44, s25, 2
s_and_b32 s44, s44, 3
s_mul_i32 s44, s44, 3
s_add_u32 s44, s44, 1
s_mul_i32 s45, s44, 5120
v_add_u32 v5, s45, v18
ds_write_b128 v5, v[72:75] offset:0
ds_write_b128 v5, v[76:79] offset:1024
ds_write_b128 v5, v[80:83] offset:2048
ds_write_b128 v5, v[84:87] offset:3072
ds_write_b128 v5, v[88:91] offset:4096
s_add_u32 s44, s25, 3
s_and_b32 s44, s44, 3
s_mul_i32 s44, s44, 3
s_add_u32 s44, s44, 2
s_mul_i32 s45, s44, 5120
v_add_u32 v5, s45, v18
ds_write_b128 v5, v[92:95] offset:0
ds_write_b128 v5, v[96:99] offset:1024
ds_write_b128 v5, v[100:103] offset:2048
ds_write_b128 v5, v[104:107] offset:3072
ds_write_b128 v5, v[108:111] offset:4096
s_waitcnt lgkmcnt(0)
v_mov_b32 v2, 161536
v_mov_b32 v3, 1
s_mov_b64 exec, 1
ds_add_u32 v2, v3 offset:68
s_mov_b64 exec, -1
v_mov_b32 v2, 161536
s_mov_b32 s47, 1048576
L_lw_49:
ds_read_b32 v3, v2 offset:68
s_waitcnt lgkmcnt(0)
v_readfirstlane_b32 s46, v3
s_nop 1
s_cmp_ge_u32 s46, 4
s_cbranch_scc1 L_lwd_50
s_sub_u32 s47, s47, 1
s_cmp_lg_u32 s47, 0
s_cbranch_scc1 L_lw_49
L_lwd_50:
s_mul_i32 s45, s25, 15360
v_add_u32 v5, s45, v18
ds_read_b128 v[52:55], v5 offset:0
ds_read_b128 v[56:59], v5 offset:1024
ds_read_b128 v[60:63], v5 offset:2048
ds_read_b128 v[64:67], v5 offset:3072
ds_read_b128 v[68:71], v5 offset:4096
ds_read_b128 v[72:75], v5 offset:5120
ds_read_b128 v[76:79], v5 offset:6144
ds_read_b128 v[80:83], v5 offset:7168
ds_read_b128 v[84:87], v5 offset:8192
ds_read_b128 v[88:91], v5 offset:9216
ds_read_b128 v[92:95], v5 offset:10240
ds_read_b128 v[96:99], v5 offset:11264
ds_read_b128 v[100:103], v5 offset:12288
ds_read_b128 v[104:107], v5 offset:13312
ds_read_b128 v[108:111], v5 offset:14336
s_waitcnt lgkmcnt(0)
v_pk_add_f32 v[32:33], v[32:33], v[52:53]
v_pk_add_f32 v[34:35], v[34:35], v[54:55]
v_pk_add_f32 v[36:37], v[36:37], v[56:57]
v_pk_add_f32 v[38:39], v[38:39], v[58:59]
v_pk_add_f32 v[40:41], v[40:41], v[60:61]
v_pk_add_f32 v[42:43], v[42:43], v[62:63]
v_pk_add_f32 v[44:45], v[44:45], v[64:65]
v_pk_add_f32 v[46:47], v[46:47], v[66:67]
v_pk_add_f32 v[48:49], v[48:49], v[68:69]
v_pk_add_f32 v[50:51], v[50:51], v[70:71]
v_pk_add_f32 v[32:33], v[32:33], v[72:73]
v_pk_add_f32 v[34:35], v[34:35], v[74:75]
v_pk_add_f32 v[36:37], v[36:37], v[76:77]
v_pk_add_f32 v[38:39], v[38:39], v[78:79]
v_pk_add_f32 v[40:41], v[40:41], v[80:81]
v_pk_add_f32 v[42:43], v[42:43], v[82:83]
v_pk_add_f32 v[44:45], v[44:45], v[84:85]
v_pk_add_f32 v[46:47], v[46:47], v[86:87]
v_pk_add_f32 v[48:49], v[48:49], v[88:89]
v_pk_add_f32 v[50:51], v[50:51], v[90:91]
v_pk_add_f32 v[32:33], v[32:33], v[92:93]
v_pk_add_f32 v[34:35], v[34:35], v[94:95]
v_pk_add_f32 v[36:37], v[36:37], v[96:97]
v_pk_add_f32 v[38:39], v[38:39], v[98:99]
v_pk_add_f32 v[40:41], v[40:41], v[100:101]
v_pk_add_f32 v[42:43], v[42:43], v[102:103]
v_pk_add_f32 v[44:45], v[44:45], v[104:105]
v_pk_add_f32 v[46:47], v[46:47], v[106:107]
v_pk_add_f32 v[48:49], v[48:49], v[108:109]
v_pk_add_f32 v[50:51], v[50:51], v[110:111]
v_mul_f32 v32, v32, v19
v_mul_f32 v33, v33, v19
v_mul_f32 v34, v34, v19
v_mul_f32 v35, v35, v19
v_mul_f32 v36, v36, v19
v_mul_f32 v37, v37, v19
v_mul_f32 v38, v38, v19
v_mul_f32 v39, v39, v19
v_mul_f32 v40, v40, v19
v_mul_f32 v41, v41, v19
v_mul_f32 v42, v42, v19
v_mul_f32 v43, v43, v19
v_mul_f32 v44, v44, v19
v_mul_f32 v45, v45, v19
v_mul_f32 v46, v46, v19
v_mul_f32 v47, v47, v19
v_mul_f32 v48, v48, v19
v_mul_f32 v49, v49, v19
v_mul_f32 v50, v50, v19
v_mul_f32 v51, v51, v19
v_cvt_pk_bf16_f32 v112, v32, v33
v_cvt_pk_bf16_f32 v113, v34, v35
v_cvt_pk_bf16_f32 v114, v36, v37
v_cvt_pk_bf16_f32 v115, v38, v39
v_cvt_pk_bf16_f32 v116, v40, v41
v_cvt_pk_bf16_f32 v117, v42, v43
v_cvt_pk_bf16_f32 v118, v44, v45
v_cvt_pk_bf16_f32 v119, v46, v47
v_cvt_pk_bf16_f32 v120, v48, v49
v_cvt_pk_bf16_f32 v121, v50, v51
s_mov_b32 s32, s18
s_mov_b32 s33, s19
s_mov_b32 s34, 2621440
s_mov_b32 s35, 0x20000
v_lshrrev_b32 v2, 4, v1
v_and_b32 v3, 15, v1
s_lshl_b32 s44, s71, 4
v_add_u32 v3, s44, v3
v_mul_u32_u24 v3, 1280, v3
v_mul_u32_u24 v2, 40, v2
s_mul_i32 s44, s27, 160
v_add3_u32 v3, v3, v2, s44
buffer_store_dwordx4 v[112:115], v3, s[32:35], 0 offen
buffer_store_dwordx4 v[116:119], v3, s[32:35], 0 offen offset:16
buffer_store_dwordx2 v[120:121], v3, s[32:35], 0 offen offset:32
s_branch L_end
L_end:
s_endpgm
.Lcode_end:
.section .rodata,"a"
.p2align 6
.amdhsa_kernel gated_mix__linear_attn_block__dense_activation_relu__prompt_kernel
  .amdhsa_next_free_vgpr 256
  .amdhsa_next_free_sgpr 102
  .amdhsa_accum_offset 160
  .amdhsa_group_segment_fixed_size 0
  .amdhsa_kernarg_size 80
  .amdhsa_user_sgpr_count 2
  .amdhsa_user_sgpr_kernarg_segment_ptr 1
  .amdhsa_system_sgpr_workgroup_id_x 1
.end_amdhsa_kernel
```
